```python
import torch

def _softmax(x, axis=-1):
    return torch.softmax(x, dim=axis)
def _gelu(x):
    return torch.nn.functional.gelu(x, approximate="tanh")
def _silu(x):
    return torch.nn.functional.silu(x)
def _sigmoid(x):
    return torch.sigmoid(x)
def _layernorm(x, axis=-1, eps=1e-5):
    m = x.mean(dim=axis, keepdim=True)
    v = x.var(dim=axis, keepdim=True, unbiased=False)
    return (x - m) / torch.sqrt(v + eps)
def _scatter_add(tgt, idx, src, axis=0):
    return tgt.clone().index_add_(axis, idx, src)
def _segment_sum(src, seg, n):
    out = torch.zeros((n,) + src.shape[1:], dtype=src.dtype)
    return out.index_add_(0, seg, src)
def _pad(x, pw):
    flat = tuple(v for pair in reversed(pw) for v in pair)
    return torch.nn.functional.pad(x, flat)

kernel_name = 'recurrent_scan__ssm_conv_s5__mixer_token_mlp__prompt'

def setup_inputs():

    _w = (lambda a: (lambda t: t.to(torch.bfloat16) if t.is_floating_point() else t)(torch.as_tensor(a)))
    def _A_setup():
        B, S, D = 1, 2048, 512
        P = D
        Lambda_re = -0.5 * (lambda _x: torch.exp(torch.as_tensor(_x)))((lambda *s: torch.randn(*s, dtype=torch.bfloat16) * 0.4)(P))
        Lambda_im = (lambda *s: torch.randn(*s, dtype=torch.bfloat16) * 0.8)(P) * 1.0
        B_re = (lambda *s: torch.randn(*s, dtype=torch.bfloat16) * 0.4)(P, D) * (D ** -0.5)
        B_im = (lambda *s: torch.randn(*s, dtype=torch.bfloat16) * 0.4)(P, D) * (D ** -0.5)
        C_re = (lambda *s: torch.randn(*s, dtype=torch.bfloat16) * 0.4)(D, P) * (P ** -0.5)
        C_im = (lambda *s: torch.randn(*s, dtype=torch.bfloat16) * 0.4)(D, P) * (P ** -0.5)
        log_dt = (lambda *s: torch.randn(*s, dtype=torch.bfloat16) * 0.4)(P) * 0.3 - 2.0
        Dskip = (lambda *s: torch.randn(*s, dtype=torch.bfloat16) * 0.2)(D)
        return {
            "x": _w((lambda *s: torch.randn(*s, dtype=torch.bfloat16) * 0.05)(B, S, D)),
            "Lambda_re": _w(Lambda_re),
            "Lambda_im": _w(Lambda_im),
            "B_re": _w(B_re),
            "B_im": _w(B_im),
            "C_re": _w(C_re),
            "C_im": _w(C_im),
            "log_dt": _w(log_dt),
            "Dskip": _w(Dskip),
        }
    _A_in = _A_setup()

    def _B_setup():
        B, S, D, F = 1, 2048, 512, 1376
        return {
            "x": _w((lambda *s: torch.randn(*s, dtype=torch.bfloat16) * 0.05)(B, S, D)),
            "w1": _w((lambda *s: torch.randn(*s, dtype=torch.bfloat16) * 0.4)(S, F) * (S ** -0.5)),
            "b1": _w((lambda *s: torch.randn(*s, dtype=torch.bfloat16) * 3.2)(F) * 0.02),
            "w2": _w((lambda *s: torch.randn(*s, dtype=torch.bfloat16) * 0.8)(F, S) * (F ** -0.5)),
            "b2": _w((lambda *s: torch.randn(*s, dtype=torch.bfloat16) * 1.6)(S) * 0.02),
        }
    _B_in = _B_setup()

    return {
        "A_x": _A_in["x"],
        "A_Lambda_re": _A_in["Lambda_re"],
        "A_Lambda_im": _A_in["Lambda_im"],
        "A_B_re": _A_in["B_re"],
        "A_B_im": _A_in["B_im"],
        "A_C_re": _A_in["C_re"],
        "A_C_im": _A_in["C_im"],
        "A_log_dt": _A_in["log_dt"],
        "A_Dskip": _A_in["Dskip"],
        "B_x": _B_in["x"],
        "B_w1": _B_in["w1"],
        "B_b1": _B_in["b1"],
        "B_w2": _B_in["w2"],
        "B_b2": _B_in["b2"],
    }

def reference(A_x, A_Lambda_re, A_Lambda_im, A_B_re, A_B_im, A_C_re, A_C_im, A_log_dt, A_Dskip, B_x, B_w1, B_b1, B_w2, B_b2):
    def _A_ref(x, Lambda_re, Lambda_im, B_re, B_im, C_re, C_im, log_dt, Dskip):
        Bsz, L, H = x.shape
        Lam = Lambda_re + 1j * Lambda_im
        Bmat = B_re + 1j * B_im
        Cmat = C_re + 1j * C_im
        dt = torch.exp(log_dt)
        Lam_bar = torch.exp(dt * Lam)
        B_bar = ((Lam_bar - 1.0) / Lam)[:, None] * Bmat
        Bu = torch.einsum("bld,pd->blp", x + 0j, B_bar)
        h = torch.zeros_like(Bu[:, 0, :])
        hs = []
        for t in range(L):
            h = Lam_bar[None, :] * h + Bu[:, t, :]
            hs.append(h)
        hseq = torch.stack(hs, 1)
        y = 2.0 * torch.einsum("blp,dp->bld", hseq, Cmat).real + x * Dskip[None, None, :]
        return y

    def _B_ref(x, w1, b1, w2, b2):
        B, S, D = x.shape
        h = _layernorm(x, axis=-1)
        u = torch.einsum("bsd,sf->bdf", h, w1) + b1
        u = _gelu(u)
        y = torch.einsum("bdf,fs->bds", u, w2) + b2
        return (lambda x, *d: x.permute(*d))(y, 0, 2, 1)

    x = A_x
    xn = _layernorm(x, axis=-1)
    s = _A_ref(xn, A_Lambda_re, A_Lambda_im, A_B_re, A_B_im, A_C_re, A_C_im, A_log_dt, A_Dskip)
    g = _silu(_B_ref(xn, B_w1, B_b1, B_w2, B_b2))
    return x + s * g
```

```asm
; @launch grid=(256,1,1) block=(256,1,1) lds=163840
.amdgcn_target "amdgcn-amd-amdhsa--gfx950"
.text
.globl recurrent_scan__ssm_conv_s5__mixer_token_mlp__prompt_kernel
.p2align 8
.type recurrent_scan__ssm_conv_s5__mixer_token_mlp__prompt_kernel,@function
recurrent_scan__ssm_conv_s5__mixer_token_mlp__prompt_kernel:
    s_cmp_ge_u32 s2, 256
    s_cbranch_scc1 kend
    s_load_dwordx16 s[4:19], s[0:1], 0
    s_load_dwordx16 s[20:35], s[0:1], 64
    s_load_dwordx2 s[36:37], s[0:1], 128
    v_and_b32 v1, 63, v0
    v_lshrrev_b32 v2, 6, v0
    s_nop 0
    v_readfirstlane_b32 s72, v2
    v_and_b32 v2, 15, v1
    v_lshrrev_b32 v3, 4, v1
    v_lshlrev_b32 v27, 4, v1
    s_bfe_u32 s3, s2, 0x20001
    s_lshl_b32 s77, s3, 3
    s_bfe_u32 s78, s2, 0x30003
    s_add_u32 s73, s77, s78
    s_and_b32 s77, s2, 1
    s_lshl_b32 s77, s77, 2
    s_lshr_b32 s78, s2, 6
    s_add_u32 s74, s77, s78
    s_mul_i32 s3, s3, 29
    s_lshr_b32 s78, s2, 3
    s_add_u32 s3, s3, s78
    s_lshr_b32 s75, s3, 2
    s_and_b32 s3, s3, 3
    s_add_u32 s76, s77, s3
    v_lshrrev_b32 v28, 3, v1
    v_and_b32 v29, 7, v1
    v_add_u32 v30, 0, v3
    v_xor_b32 v30, v29, v30
    v_lshlrev_b32 v30, 4, v30
    v_add_u32 v31, 0, v28
    v_lshl_add_u32 v6, v31, 10, v30
    v_lshrrev_b32 v31, 5, v1
    v_add_u32 v31, 0, v31
    v_lshlrev_b32 v31, 4, v31
    v_and_b32 v26, 3, v28
    v_add_u32 v31, v31, v26
    v_lshl_add_u32 v4, v31, 10, v30
    v_add_u32 v30, 4, v3
    v_xor_b32 v30, v29, v30
    v_lshlrev_b32 v30, 4, v30
    v_add_u32 v31, 8, v28
    v_lshl_add_u32 v7, v31, 10, v30
    v_lshrrev_b32 v31, 5, v1
    v_add_u32 v31, 2, v31
    v_lshlrev_b32 v31, 4, v31
    v_and_b32 v26, 3, v28
    v_add_u32 v31, v31, v26
    v_lshl_add_u32 v5, v31, 10, v30
    v_lshrrev_b32 v30, 1, v2
    v_xor_b32 v30, v30, v3
    v_lshlrev_b32 v30, 4, v30
    v_lshl_add_u32 v8, v2, 7, v30
    v_xor_b32 v9, 64, v8
    s_lshl_b32 s79, s72, 14
    s_add_u32 s79, s79, 65536
    v_add_u32 v10, s79, v8
    v_add_u32 v11, s79, v9
    s_lshl_b32 s77, s73, 3
    s_add_u32 s3, s77, s74
    s_lshl_b32 s77, s74, 6
    s_lshl_b32 s78, s72, 4
    s_add_u32 s77, s77, s78
    v_add_u32 v30, s77, v2
    v_lshlrev_b32 v30, 1, v30
    v_lshlrev_b32 v31, 3, v2
    s_lshl_b32 s78, s74, 7
    v_add_u32 v31, s78, v31
    s_lshl_b32 s78, s73, 7
    s_lshl_b32 s38, s72, 5
    s_add_u32 s78, s78, s38
    v_lshlrev_b32 v29, 1, v3
    v_add_u32 v29, s78, v29
    v_mov_b32 v28, 15777792
    s_waitcnt lgkmcnt(0)
    s_mov_b32 s22, s3
    s_mov_b32 s23, s77
    s_mov_b32 s40, s4
    s_and_b32 s41, s5, 0xffff
    s_mov_b32 s42, 2097152
    s_mov_b32 s43, 0x20000
    s_lshl_b32 s38, s22, 13
    s_lshl_b32 s39, s72, 11
    s_add_u32 s38, s38, s39
    buffer_load_dwordx4 v[12:15], v27, s[40:43], s38 offen
    buffer_load_dwordx4 v[16:19], v27, s[40:43], s38 offen offset:1024
    s_mov_b32 s52, s24
    s_and_b32 s53, s25, 0xffff
    s_mov_b32 s54, 5636096
    s_mov_b32 s55, 0x20000
    s_mul_i32 s77, s22, 22016
    s_mul_i32 s78, s72, 5504
    s_add_u32 s77, s77, s78
    s_add_u32 m0, s78, 131072
    s_nop 0
    buffer_load_dwordx4 v27, s[52:55], s77 offen offset:0 nt lds
    buffer_load_dwordx4 v27, s[52:55], s77 offen offset:1024 nt lds
    buffer_load_dwordx4 v27, s[52:55], s77 offen offset:2048 nt lds
    buffer_load_dwordx4 v27, s[52:55], s77 offen offset:3072 nt lds
    s_add_u32 m0, m0, 4096
    s_add_u32 s77, s77, 4096
    buffer_load_dwordx4 v27, s[52:55], s77 offen offset:0 nt lds
    buffer_load_dwordx4 v27, s[52:55], s77 offen offset:1024 nt lds
    global_load_dword v237, v28, s[36:37] sc1
    s_and_b32 s77, s2, 1
    s_lshl_b32 s77, s77, 8
    s_and_b32 s78, s2, 0xf8
    s_add_u32 s77, s77, s78
    s_and_b32 s78, s72, 1
    s_lshl_b32 s78, s78, 2
    s_add_u32 s77, s77, s78
    s_lshl_b32 s77, s77, 10
    v_and_b32 v249, 31, v1
    v_lshlrev_b32 v249, 7, v249
    v_add_u32 v249, s77, v249
    s_cmp_lt_u32 s72, 2
    s_cselect_b32 s68, s10, s12
    s_cselect_b32 s69, s11, s13
    global_load_dword v250, v249, s[68:69]
    s_mov_b32 s44, s10
    s_and_b32 s45, s11, 0xffff
    s_mov_b32 s46, 524288
    s_mov_b32 s47, 0x20000
    s_mov_b32 s48, s12
    s_and_b32 s49, s13, 0xffff
    s_mov_b32 s50, 524288
    s_mov_b32 s51, 0x20000
    s_lshl_b32 s4, s74, 1
    s_add_u32 s4, s4, s73
    s_and_b32 s4, s4, 7
    s_lshl_b32 s4, s4, 7
    s_lshl_b32 s34, s23, 10
    s_or_b32 s34, s34, s4
    s_lshl_b32 s35, s73, 16
    s_lshl_b32 s78, s72, 12
    s_add_u32 s35, s35, s78
    s_or_b32 s35, s35, s4
    v_subrev_u32 v5, 1024, v5
    v_subrev_u32 v7, 1024, v7
    s_add_u32 m0, s79, 0
    s_xor_b32 s5, s34, 0
    buffer_load_dwordx4 v6, s[44:47], s5 offen lds
    buffer_load_dwordx4 v7, s[44:47], s5 offen offset:1024 lds
    s_add_u32 m0, s79, 8192
    s_nop 0
    buffer_load_dwordx4 v6, s[48:51], s5 offen lds
    buffer_load_dwordx4 v7, s[48:51], s5 offen offset:1024 lds
    v_mov_b32 v201, v30
    v_mov_b32 v202, v31
    v_mov_b32 v203, v29
    v_lshlrev_b32 v248, 10, v2
    v_lshl_add_u32 v248, v3, 4, v248
    s_and_b32 s77, s73, 7
    s_lshl_b32 s77, s77, 13
    s_lshl_b32 s3, s74, 16
    s_add_u32 s77, s77, s3
    s_add_u32 s77, s77, s39
    v_add_u32 v23, s77, v27
    s_add_u32 s56, s36, 0
    s_addc_u32 s57, s37, 0
    s_and_b32 s57, s57, 0xffff
    s_mov_b32 s58, 2097152
    s_mov_b32 s59, 0x20000
    s_add_u32 s64, s36, 15728640
    s_addc_u32 s65, s37, 0
    s_and_b32 s65, s65, 0xffff
    s_mov_b32 s66, 458752
    s_mov_b32 s67, 0x20000
    s_mul_i32 s77, s22, 22272
    s_add_u32 s77, s77, 2097152
    s_add_u32 s60, s36, s77
    s_addc_u32 s61, s37, 0
    s_and_b32 s61, s61, 0xffff
    s_mov_b32 s62, 22016
    s_mov_b32 s63, 0x20000
    s_cmp_lt_u32 s72, 2
    s_cselect_b32 s68, s14, s16
    s_cselect_b32 s69, s15, s17
    s_and_b32 s69, s69, 0xffff
    s_mov_b32 s70, 0x80000
    s_mov_b32 s71, 0x20000
    v_and_b32 v28, 3, v1
    v_lshlrev_b32 v28, 3, v28
    v_lshl_add_u32 v28, v3, 5, v28
    v_lshrrev_b32 v29, 2, v2
    v_mov_b32 v30, 1088
    v_mad_u32_u24 v20, v29, v30, v28
    s_lshl_b32 s77, s72, 8
    s_add_u32 s77, s77, 153728
    v_add_u32 v20, s77, v20
    v_mov_b32 v30, 2752
    v_mad_u32_u24 v21, v29, v30, v28
    s_lshl_b32 s77, s72, 7
    s_add_u32 s77, s77, 131072
    v_add_u32 v21, s77, v21
    s_mul_i32 s77, s72, 2176
    s_add_u32 s77, s77, 153728
    v_add_u32 v22, s77, v27
    v_lshrrev_b32 v30, 1, v2
    v_lshrrev_b32 v31, 5, v1
    s_lshl_b32 s77, s72, 1
    v_add_u32 v31, s77, v31
    v_xor_b32 v30, v30, v31
    v_lshlrev_b32 v30, 4, v30
    v_and_b32 v31, 1, v1
    v_lshl_add_u32 v30, v31, 3, v30
    v_lshl_add_u32 v30, v3, 7, v30
    s_lshl_b32 s77, s72, 9
    s_lshl_b32 s78, s74, 7
    s_xor_b32 s78, s78, s4
    s_lshl_b32 s78, s78, 6
    s_add_u32 s77, s77, s78
    v_add_u32 v200, s77, v30
    v_mov_b32 v104, 0x3f803f80
    v_mov_b32 v105, 0x3f803f80
    v_mov_b32 v106, 0x3f803f80
    v_mov_b32 v107, 0x3f803f80
    v_cmp_eq_u32 s[10:11], 1, v1
    s_mul_i32 s24, s72, 24576
    s_add_u32 s24, s24, 65536
    s_lshl_b32 s25, s72, 14
    s_lshl_b32 s12, s72, 13
    s_waitcnt vmcnt(12)
    v_lshlrev_b32 v32, 16, v12
    v_and_b32 v33, 0xffff0000, v12
    v_lshlrev_b32 v34, 16, v13
    v_and_b32 v35, 0xffff0000, v13
    v_lshlrev_b32 v36, 16, v14
    v_and_b32 v37, 0xffff0000, v14
    v_lshlrev_b32 v38, 16, v15
    v_and_b32 v39, 0xffff0000, v15
    v_lshlrev_b32 v40, 16, v16
    v_and_b32 v41, 0xffff0000, v16
    v_lshlrev_b32 v42, 16, v17
    v_and_b32 v43, 0xffff0000, v17
    v_lshlrev_b32 v44, 16, v18
    v_and_b32 v45, 0xffff0000, v18
    v_lshlrev_b32 v46, 16, v19
    v_and_b32 v47, 0xffff0000, v19
    v_add_f32 v140, v32, v33
    v_add_f32 v142, v34, v35
    v_add_f32 v140, v140, v36
    v_add_f32 v142, v142, v37
    v_add_f32 v140, v140, v38
    v_add_f32 v142, v142, v39
    v_add_f32 v140, v140, v142
    v_add_f32 v141, v40, v41
    v_add_f32 v143, v42, v43
    v_add_f32 v141, v141, v44
    v_add_f32 v143, v143, v45
    v_add_f32 v141, v141, v46
    v_add_f32 v143, v143, v47
    v_add_f32 v141, v141, v143
    v_add_f32_dpp v140, v140, v140 quad_perm:[1,0,3,2] row_mask:0xf bank_mask:0xf
    s_nop 0
    v_add_f32_dpp v141, v141, v141 quad_perm:[1,0,3,2] row_mask:0xf bank_mask:0xf
    v_add_f32_dpp v140, v140, v140 quad_perm:[2,3,0,1] row_mask:0xf bank_mask:0xf
    s_nop 0
    v_add_f32_dpp v141, v141, v141 quad_perm:[2,3,0,1] row_mask:0xf bank_mask:0xf
    v_add_f32_dpp v140, v140, v140 row_half_mirror row_mask:0xf bank_mask:0xf
    s_nop 0
    v_add_f32_dpp v141, v141, v141 row_half_mirror row_mask:0xf bank_mask:0xf
    v_add_f32_dpp v140, v140, v140 row_mirror row_mask:0xf bank_mask:0xf
    s_nop 0
    v_add_f32_dpp v141, v141, v141 row_mirror row_mask:0xf bank_mask:0xf
    v_mov_b32 v142, v140
    v_mov_b32 v143, v141
    s_nop 0
    v_permlane16_swap_b32 v142, v140
    v_permlane16_swap_b32 v143, v141
    v_add_f32 v140, v140, v142
    v_add_f32 v141, v141, v143
    v_mov_b32 v142, v140
    v_mov_b32 v143, v141
    s_nop 0
    v_permlane32_swap_b32 v142, v140
    v_permlane32_swap_b32 v143, v141
    v_add_f32 v140, v140, v142
    v_add_f32 v141, v141, v143
    v_mul_f32 v140, 0x3b000000, v140
    v_cvt_pk_bf16_f32 v144, v140, v140
    v_lshlrev_b32 v144, 16, v144
    v_mul_f32 v141, 0x3b000000, v141
    v_cvt_pk_bf16_f32 v145, v141, v141
    v_lshlrev_b32 v145, 16, v145
    v_sub_f32 v48, v32, v140
    v_sub_f32 v49, v33, v140
    v_sub_f32 v50, v34, v140
    v_sub_f32 v51, v35, v140
    v_sub_f32 v52, v36, v140
    v_sub_f32 v53, v37, v140
    v_sub_f32 v54, v38, v140
    v_sub_f32 v55, v39, v140
    v_sub_f32 v56, v40, v141
    v_sub_f32 v57, v41, v141
    v_sub_f32 v58, v42, v141
    v_sub_f32 v59, v43, v141
    v_sub_f32 v60, v44, v141
    v_sub_f32 v61, v45, v141
    v_sub_f32 v62, v46, v141
    v_sub_f32 v63, v47, v141
    v_mul_f32 v140, v48, v48
    v_mul_f32 v142, v49, v49
    v_fmac_f32 v140, v50, v50
    v_fmac_f32 v142, v51, v51
    v_fmac_f32 v140, v52, v52
    v_fmac_f32 v142, v53, v53
    v_fmac_f32 v140, v54, v54
    v_fmac_f32 v142, v55, v55
    v_add_f32 v140, v140, v142
    v_mul_f32 v141, v56, v56
    v_mul_f32 v143, v57, v57
    v_fmac_f32 v141, v58, v58
    v_fmac_f32 v143, v59, v59
    v_fmac_f32 v141, v60, v60
    v_fmac_f32 v143, v61, v61
    v_fmac_f32 v141, v62, v62
    v_fmac_f32 v143, v63, v63
    v_add_f32 v141, v141, v143
    v_add_f32_dpp v140, v140, v140 quad_perm:[1,0,3,2] row_mask:0xf bank_mask:0xf
    s_nop 0
    v_add_f32_dpp v141, v141, v141 quad_perm:[1,0,3,2] row_mask:0xf bank_mask:0xf
    v_add_f32_dpp v140, v140, v140 quad_perm:[2,3,0,1] row_mask:0xf bank_mask:0xf
    s_nop 0
    v_add_f32_dpp v141, v141, v141 quad_perm:[2,3,0,1] row_mask:0xf bank_mask:0xf
    v_add_f32_dpp v140, v140, v140 row_half_mirror row_mask:0xf bank_mask:0xf
    s_nop 0
    v_add_f32_dpp v141, v141, v141 row_half_mirror row_mask:0xf bank_mask:0xf
    v_add_f32_dpp v140, v140, v140 row_mirror row_mask:0xf bank_mask:0xf
    s_nop 0
    v_add_f32_dpp v141, v141, v141 row_mirror row_mask:0xf bank_mask:0xf
    v_mov_b32 v142, v140
    v_mov_b32 v143, v141
    s_nop 0
    v_permlane16_swap_b32 v142, v140
    v_permlane16_swap_b32 v143, v141
    v_add_f32 v140, v140, v142
    v_add_f32 v141, v141, v143
    v_mov_b32 v142, v140
    v_mov_b32 v143, v141
    s_nop 0
    v_permlane32_swap_b32 v142, v140
    v_permlane32_swap_b32 v143, v141
    v_add_f32 v140, v140, v142
    v_add_f32 v141, v141, v143
    v_sub_f32 v48, v32, v144
    v_sub_f32 v49, v33, v144
    v_sub_f32 v50, v34, v144
    v_sub_f32 v51, v35, v144
    v_sub_f32 v52, v36, v144
    v_sub_f32 v53, v37, v144
    v_sub_f32 v54, v38, v144
    v_sub_f32 v55, v39, v144
    v_sub_f32 v56, v40, v145
    v_sub_f32 v57, v41, v145
    v_sub_f32 v58, v42, v145
    v_sub_f32 v59, v43, v145
    v_sub_f32 v60, v44, v145
    v_sub_f32 v61, v45, v145
    v_sub_f32 v62, v46, v145
    v_sub_f32 v63, v47, v145
    v_mul_f32 v140, 0x3b000000, v140
    v_mul_f32 v141, 0x3b000000, v141
    v_cvt_pk_bf16_f32 v140, v140, v140
    v_lshlrev_b32 v140, 16, v140
    v_cvt_pk_bf16_f32 v141, v141, v141
    v_lshlrev_b32 v141, 16, v141
    v_add_f32 v140, 0x3727c5ac, v140
    v_add_f32 v141, 0x3727c5ac, v141
    v_cvt_pk_bf16_f32 v140, v140, v140
    v_lshlrev_b32 v140, 16, v140
    v_cvt_pk_bf16_f32 v141, v141, v141
    v_lshlrev_b32 v141, 16, v141
    v_sqrt_f32 v140, v140
    v_sqrt_f32 v141, v141
    v_cvt_pk_bf16_f32 v12, v48, v49
    v_cvt_pk_bf16_f32 v13, v50, v51
    v_cvt_pk_bf16_f32 v14, v52, v53
    v_cvt_pk_bf16_f32 v15, v54, v55
    v_cvt_pk_bf16_f32 v16, v56, v57
    v_cvt_pk_bf16_f32 v17, v58, v59
    v_cvt_pk_bf16_f32 v18, v60, v61
    v_cvt_pk_bf16_f32 v19, v62, v63
    v_cvt_pk_bf16_f32 v140, v140, v140
    v_lshlrev_b32 v140, 16, v140
    v_cvt_pk_bf16_f32 v141, v141, v141
    v_lshlrev_b32 v141, 16, v141
    v_rcp_f32 v140, v140
    v_rcp_f32 v141, v141
    v_lshlrev_b32 v48, 16, v12
    v_and_b32 v49, 0xffff0000, v12
    v_lshlrev_b32 v50, 16, v13
    v_and_b32 v51, 0xffff0000, v13
    v_lshlrev_b32 v52, 16, v14
    v_and_b32 v53, 0xffff0000, v14
    v_lshlrev_b32 v54, 16, v15
    v_and_b32 v55, 0xffff0000, v15
    v_lshlrev_b32 v56, 16, v16
    v_and_b32 v57, 0xffff0000, v16
    v_lshlrev_b32 v58, 16, v17
    v_and_b32 v59, 0xffff0000, v17
    v_lshlrev_b32 v60, 16, v18
    v_and_b32 v61, 0xffff0000, v18
    v_lshlrev_b32 v62, 16, v19
    v_and_b32 v63, 0xffff0000, v19
    v_mul_f32 v48, v48, v140
    v_mul_f32 v49, v49, v140
    v_mul_f32 v50, v50, v140
    v_mul_f32 v51, v51, v140
    v_mul_f32 v52, v52, v140
    v_mul_f32 v53, v53, v140
    v_mul_f32 v54, v54, v140
    v_mul_f32 v55, v55, v140
    v_mul_f32 v56, v56, v141
    v_mul_f32 v57, v57, v141
    v_mul_f32 v58, v58, v141
    v_mul_f32 v59, v59, v141
    v_mul_f32 v60, v60, v141
    v_mul_f32 v61, v61, v141
    v_mul_f32 v62, v62, v141
    v_mul_f32 v63, v63, v141
    v_cvt_pk_bf16_f32 v12, v48, v49
    v_cvt_pk_bf16_f32 v13, v50, v51
    v_cvt_pk_bf16_f32 v14, v52, v53
    v_cvt_pk_bf16_f32 v15, v54, v55
    v_cvt_pk_bf16_f32 v16, v56, v57
    v_cvt_pk_bf16_f32 v17, v58, v59
    v_cvt_pk_bf16_f32 v18, v60, v61
    v_cvt_pk_bf16_f32 v19, v62, v63
    v_lshlrev_b32 v32, 16, v12
    v_and_b32 v33, 0xffff0000, v12
    v_lshlrev_b32 v34, 16, v13
    v_and_b32 v35, 0xffff0000, v13
    v_lshlrev_b32 v36, 16, v14
    v_and_b32 v37, 0xffff0000, v14
    v_lshlrev_b32 v38, 16, v15
    v_and_b32 v39, 0xffff0000, v15
    v_lshlrev_b32 v40, 16, v16
    v_and_b32 v41, 0xffff0000, v16
    v_lshlrev_b32 v42, 16, v17
    v_and_b32 v43, 0xffff0000, v17
    v_lshlrev_b32 v44, 16, v18
    v_and_b32 v45, 0xffff0000, v18
    v_lshlrev_b32 v46, 16, v19
    v_and_b32 v47, 0xffff0000, v19
    v_cndmask_b32 v148, v144, v145, s[10:11]
    v_cndmask_b32 v149, v140, v141, s[10:11]
    v_add_f32 v140, v32, v33
    v_add_f32 v142, v34, v35
    v_add_f32 v140, v140, v36
    v_add_f32 v142, v142, v37
    v_add_f32 v140, v140, v38
    v_add_f32 v142, v142, v39
    v_add_f32 v140, v140, v142
    v_add_f32 v141, v40, v41
    v_add_f32 v143, v42, v43
    v_add_f32 v141, v141, v44
    v_add_f32 v143, v143, v45
    v_add_f32 v141, v141, v46
    v_add_f32 v143, v143, v47
    v_add_f32 v141, v141, v143
    v_add_f32_dpp v140, v140, v140 quad_perm:[1,0,3,2] row_mask:0xf bank_mask:0xf
    s_nop 0
    v_add_f32_dpp v141, v141, v141 quad_perm:[1,0,3,2] row_mask:0xf bank_mask:0xf
    v_add_f32_dpp v140, v140, v140 quad_perm:[2,3,0,1] row_mask:0xf bank_mask:0xf
    s_nop 0
    v_add_f32_dpp v141, v141, v141 quad_perm:[2,3,0,1] row_mask:0xf bank_mask:0xf
    v_add_f32_dpp v140, v140, v140 row_half_mirror row_mask:0xf bank_mask:0xf
    s_nop 0
    v_add_f32_dpp v141, v141, v141 row_half_mirror row_mask:0xf bank_mask:0xf
    v_add_f32_dpp v140, v140, v140 row_mirror row_mask:0xf bank_mask:0xf
    s_nop 0
    v_add_f32_dpp v141, v141, v141 row_mirror row_mask:0xf bank_mask:0xf
    v_mov_b32 v142, v140
    v_mov_b32 v143, v141
    s_nop 0
    v_permlane16_swap_b32 v142, v140
    v_permlane16_swap_b32 v143, v141
    v_add_f32 v140, v140, v142
    v_add_f32 v141, v141, v143
    v_mov_b32 v142, v140
    v_mov_b32 v143, v141
    s_nop 0
    v_permlane32_swap_b32 v142, v140
    v_permlane32_swap_b32 v143, v141
    v_add_f32 v140, v140, v142
    v_add_f32 v141, v141, v143
    v_mul_f32 v140, 0x3b000000, v140
    v_cvt_pk_bf16_f32 v144, v140, v140
    v_lshlrev_b32 v144, 16, v144
    v_mul_f32 v141, 0x3b000000, v141
    v_cvt_pk_bf16_f32 v145, v141, v141
    v_lshlrev_b32 v145, 16, v145
    v_sub_f32 v48, v32, v140
    v_sub_f32 v49, v33, v140
    v_sub_f32 v50, v34, v140
    v_sub_f32 v51, v35, v140
    v_sub_f32 v52, v36, v140
    v_sub_f32 v53, v37, v140
    v_sub_f32 v54, v38, v140
    v_sub_f32 v55, v39, v140
    v_sub_f32 v56, v40, v141
    v_sub_f32 v57, v41, v141
    v_sub_f32 v58, v42, v141
    v_sub_f32 v59, v43, v141
    v_sub_f32 v60, v44, v141
    v_sub_f32 v61, v45, v141
    v_sub_f32 v62, v46, v141
    v_sub_f32 v63, v47, v141
    v_mul_f32 v140, v48, v48
    v_mul_f32 v142, v49, v49
    v_fmac_f32 v140, v50, v50
    v_fmac_f32 v142, v51, v51
    v_fmac_f32 v140, v52, v52
    v_fmac_f32 v142, v53, v53
    v_fmac_f32 v140, v54, v54
    v_fmac_f32 v142, v55, v55
    v_add_f32 v140, v140, v142
    v_mul_f32 v141, v56, v56
    v_mul_f32 v143, v57, v57
    v_fmac_f32 v141, v58, v58
    v_fmac_f32 v143, v59, v59
    v_fmac_f32 v141, v60, v60
    v_fmac_f32 v143, v61, v61
    v_fmac_f32 v141, v62, v62
    v_fmac_f32 v143, v63, v63
    v_add_f32 v141, v141, v143
    v_add_f32_dpp v140, v140, v140 quad_perm:[1,0,3,2] row_mask:0xf bank_mask:0xf
    s_nop 0
    v_add_f32_dpp v141, v141, v141 quad_perm:[1,0,3,2] row_mask:0xf bank_mask:0xf
    v_add_f32_dpp v140, v140, v140 quad_perm:[2,3,0,1] row_mask:0xf bank_mask:0xf
    s_nop 0
    v_add_f32_dpp v141, v141, v141 quad_perm:[2,3,0,1] row_mask:0xf bank_mask:0xf
    v_add_f32_dpp v140, v140, v140 row_half_mirror row_mask:0xf bank_mask:0xf
    s_nop 0
    v_add_f32_dpp v141, v141, v141 row_half_mirror row_mask:0xf bank_mask:0xf
    v_add_f32_dpp v140, v140, v140 row_mirror row_mask:0xf bank_mask:0xf
    s_nop 0
    v_add_f32_dpp v141, v141, v141 row_mirror row_mask:0xf bank_mask:0xf
    v_mov_b32 v142, v140
    v_mov_b32 v143, v141
    s_nop 0
    v_permlane16_swap_b32 v142, v140
    v_permlane16_swap_b32 v143, v141
    v_add_f32 v140, v140, v142
    v_add_f32 v141, v141, v143
    v_mov_b32 v142, v140
    v_mov_b32 v143, v141
    s_nop 0
    v_permlane32_swap_b32 v142, v140
    v_permlane32_swap_b32 v143, v141
    v_add_f32 v140, v140, v142
    v_add_f32 v141, v141, v143
    v_sub_f32 v48, v32, v144
    v_sub_f32 v49, v33, v144
    v_sub_f32 v50, v34, v144
    v_sub_f32 v51, v35, v144
    v_sub_f32 v52, v36, v144
    v_sub_f32 v53, v37, v144
    v_sub_f32 v54, v38, v144
    v_sub_f32 v55, v39, v144
    v_sub_f32 v56, v40, v145
    v_sub_f32 v57, v41, v145
    v_sub_f32 v58, v42, v145
    v_sub_f32 v59, v43, v145
    v_sub_f32 v60, v44, v145
    v_sub_f32 v61, v45, v145
    v_sub_f32 v62, v46, v145
    v_sub_f32 v63, v47, v145
    v_mul_f32 v140, 0x3b000000, v140
    v_mul_f32 v141, 0x3b000000, v141
    v_cvt_pk_bf16_f32 v140, v140, v140
    v_lshlrev_b32 v140, 16, v140
    v_cvt_pk_bf16_f32 v141, v141, v141
    v_lshlrev_b32 v141, 16, v141
    v_add_f32 v140, 0x3727c5ac, v140
    v_add_f32 v141, 0x3727c5ac, v141
    v_cvt_pk_bf16_f32 v140, v140, v140
    v_lshlrev_b32 v140, 16, v140
    v_cvt_pk_bf16_f32 v141, v141, v141
    v_lshlrev_b32 v141, 16, v141
    v_sqrt_f32 v140, v140
    v_sqrt_f32 v141, v141
    v_cvt_pk_bf16_f32 v12, v48, v49
    v_cvt_pk_bf16_f32 v13, v50, v51
    v_cvt_pk_bf16_f32 v14, v52, v53
    v_cvt_pk_bf16_f32 v15, v54, v55
    v_cvt_pk_bf16_f32 v16, v56, v57
    v_cvt_pk_bf16_f32 v17, v58, v59
    v_cvt_pk_bf16_f32 v18, v60, v61
    v_cvt_pk_bf16_f32 v19, v62, v63
    v_cvt_pk_bf16_f32 v140, v140, v140
    v_lshlrev_b32 v140, 16, v140
    v_cvt_pk_bf16_f32 v141, v141, v141
    v_lshlrev_b32 v141, 16, v141
    v_rcp_f32 v140, v140
    v_rcp_f32 v141, v141
    v_lshlrev_b32 v48, 16, v12
    v_and_b32 v49, 0xffff0000, v12
    v_lshlrev_b32 v50, 16, v13
    v_and_b32 v51, 0xffff0000, v13
    v_lshlrev_b32 v52, 16, v14
    v_and_b32 v53, 0xffff0000, v14
    v_lshlrev_b32 v54, 16, v15
    v_and_b32 v55, 0xffff0000, v15
    v_lshlrev_b32 v56, 16, v16
    v_and_b32 v57, 0xffff0000, v16
    v_lshlrev_b32 v58, 16, v17
    v_and_b32 v59, 0xffff0000, v17
    v_lshlrev_b32 v60, 16, v18
    v_and_b32 v61, 0xffff0000, v18
    v_lshlrev_b32 v62, 16, v19
    v_and_b32 v63, 0xffff0000, v19
    v_mul_f32 v48, v48, v140
    v_mul_f32 v49, v49, v140
    v_mul_f32 v50, v50, v140
    v_mul_f32 v51, v51, v140
    v_mul_f32 v52, v52, v140
    v_mul_f32 v53, v53, v140
    v_mul_f32 v54, v54, v140
    v_mul_f32 v55, v55, v140
    v_mul_f32 v56, v56, v141
    v_mul_f32 v57, v57, v141
    v_mul_f32 v58, v58, v141
    v_mul_f32 v59, v59, v141
    v_mul_f32 v60, v60, v141
    v_mul_f32 v61, v61, v141
    v_mul_f32 v62, v62, v141
    v_mul_f32 v63, v63, v141
    v_cvt_pk_bf16_f32 v12, v48, v49
    v_cvt_pk_bf16_f32 v13, v50, v51
    v_cvt_pk_bf16_f32 v14, v52, v53
    v_cvt_pk_bf16_f32 v15, v54, v55
    v_cvt_pk_bf16_f32 v16, v56, v57
    v_cvt_pk_bf16_f32 v17, v58, v59
    v_cvt_pk_bf16_f32 v18, v60, v61
    v_cvt_pk_bf16_f32 v19, v62, v63
    ds_write_b128 v22, v[12:15]
    ds_write_b128 v22, v[16:19] offset:1088
    s_add_u32 m0, s79, 2048
    s_xor_b32 s5, s34, 128
    buffer_load_dwordx4 v6, s[44:47], s5 offen lds
    buffer_load_dwordx4 v7, s[44:47], s5 offen offset:1024 lds
    s_add_u32 m0, s79, 10240
    s_nop 0
    buffer_load_dwordx4 v6, s[48:51], s5 offen lds
    buffer_load_dwordx4 v7, s[48:51], s5 offen offset:1024 lds
    s_add_u32 m0, s79, 4096
    s_xor_b32 s5, s34, 256
    buffer_load_dwordx4 v6, s[44:47], s5 offen lds
    buffer_load_dwordx4 v7, s[44:47], s5 offen offset:1024 lds
    s_add_u32 m0, s79, 12288
    s_nop 0
    buffer_load_dwordx4 v6, s[48:51], s5 offen lds
    buffer_load_dwordx4 v7, s[48:51], s5 offen offset:1024 lds
    s_add_u32 m0, s79, 6144
    s_xor_b32 s5, s34, 384
    buffer_load_dwordx4 v6, s[44:47], s5 offen lds
    buffer_load_dwordx4 v7, s[44:47], s5 offen offset:1024 lds
    s_add_u32 m0, s79, 14336
    s_nop 0
    buffer_load_dwordx4 v6, s[48:51], s5 offen lds
    buffer_load_dwordx4 v7, s[48:51], s5 offen offset:1024 lds
    s_add_u32 m0, s39, 0
    s_xor_b32 s5, s35, 0
    buffer_load_dwordx4 v4, s[40:43], s5 offen lds
    buffer_load_dwordx4 v5, s[40:43], s5 offen offset:1024 lds
    s_add_u32 m0, s39, 8192
    s_xor_b32 s5, s35, 128
    buffer_load_dwordx4 v4, s[40:43], s5 offen lds
    buffer_load_dwordx4 v5, s[40:43], s5 offen offset:1024 lds
    s_add_u32 m0, s39, 16384
    s_xor_b32 s5, s35, 256
    buffer_load_dwordx4 v4, s[40:43], s5 offen lds
    buffer_load_dwordx4 v5, s[40:43], s5 offen offset:1024 lds
    s_add_u32 m0, s39, 24576
    s_xor_b32 s5, s35, 384
    buffer_load_dwordx4 v4, s[40:43], s5 offen lds
    buffer_load_dwordx4 v5, s[40:43], s5 offen offset:1024 lds
    s_add_u32 m0, s39, 32768
    s_xor_b32 s5, s35, 512
    buffer_load_dwordx4 v4, s[40:43], s5 offen lds
    buffer_load_dwordx4 v5, s[40:43], s5 offen offset:1024 lds
    s_add_u32 m0, s39, 40960
    s_xor_b32 s5, s35, 640
    buffer_load_dwordx4 v4, s[40:43], s5 offen lds
    buffer_load_dwordx4 v5, s[40:43], s5 offen offset:1024 lds
    s_add_u32 m0, s39, 49152
    s_xor_b32 s5, s35, 768
    buffer_load_dwordx4 v4, s[40:43], s5 offen lds
    buffer_load_dwordx4 v5, s[40:43], s5 offen offset:1024 lds
    s_add_u32 m0, s39, 57344
    s_xor_b32 s5, s35, 896
    buffer_load_dwordx4 v4, s[40:43], s5 offen lds
    buffer_load_dwordx4 v5, s[40:43], s5 offen offset:1024 lds
    global_load_dwordx4 v[252:255], v23, s[14:15] offset:0
    global_load_dwordx4 v[252:255], v23, s[14:15] offset:1024
    global_load_dwordx4 v[252:255], v23, s[16:17] offset:0
    global_load_dwordx4 v[252:255], v23, s[16:17] offset:1024
    global_load_ushort v24, v201, s[6:7]
    global_load_ushort v25, v201, s[8:9]
    global_load_ushort v26, v201, s[18:19]
    global_load_dwordx2 v[214:215], v202, s[20:21]
    global_load_ushort v232, v203, s[30:31] offset:0
    global_load_ushort v233, v203, s[30:31] offset:8
    global_load_ushort v234, v203, s[30:31] offset:16
    global_load_ushort v235, v203, s[30:31] offset:24
    s_waitcnt vmcnt(45) lgkmcnt(0)
    s_barrier
    ds_read_b64_tr_b16 v[168:169], v20 offset:0
    ds_read_b64_tr_b16 v[170:171], v20 offset:4352
    ds_read_b64_tr_b16 v[172:173], v20 offset:128
    ds_read_b64_tr_b16 v[174:175], v20 offset:4480
    ds_read_b64_tr_b16 v[176:177], v21 offset:0
    ds_read_b64_tr_b16 v[178:179], v21 offset:11008
    ds_read_b64_tr_b16 v[180:181], v21 offset:512
    ds_read_b64_tr_b16 v[182:183], v21 offset:11520
    ds_read_b64_tr_b16 v[184:185], v21 offset:1024
    ds_read_b64_tr_b16 v[186:187], v21 offset:12032
    ds_read_b64_tr_b16 v[188:189], v21 offset:1536
    ds_read_b64_tr_b16 v[190:191], v21 offset:12544
    ds_read_b64_tr_b16 v[192:193], v21 offset:2048
    ds_read_b64_tr_b16 v[194:195], v21 offset:13056
    ds_read_b64_tr_b16 v[196:197], v21 offset:2560
    ds_read_b64_tr_b16 v[198:199], v21 offset:13568
    s_lshl_b32 s77, s72, 10
    v_mov_b32 v30, 0x9e3779b1
    v_mul_lo_u32 v236, v237, v30
    v_xor_b32 v236, 0x5bd1e995, v236
    v_or_b32 v236, 1, v236
    v_mov_b32 v150, v236
    s_lshr_b32 s78, s38, 6
    s_add_u32 s78, s78, 65536
    s_mov_b64 exec, 3
    buffer_store_dwordx4 v[148:151], v27, s[64:67], s78 offen sc1
    s_mov_b64 exec, -1
    s_waitcnt lgkmcnt(12)
    buffer_store_dwordx4 v[168:171], v27, s[56:59], s38 offen sc1
    buffer_store_dwordx4 v[172:175], v27, s[56:59], s38 offen offset:1024 sc1
    s_waitcnt lgkmcnt(10)
    buffer_store_dwordx4 v[176:179], v27, s[60:63], s77 offen sc1
    s_add_u32 s77, s77, 4096
    s_waitcnt lgkmcnt(8)
    buffer_store_dwordx4 v[180:183], v27, s[60:63], s77 offen sc1
    s_add_u32 s77, s77, 4096
    s_waitcnt lgkmcnt(6)
    buffer_store_dwordx4 v[184:187], v27, s[60:63], s77 offen sc1
    s_add_u32 s77, s77, 4096
    s_waitcnt lgkmcnt(0)
    buffer_store_dwordx4 v[188:191], v27, s[60:63], s77 offen sc1
    s_add_u32 s77, s77, 4096
    buffer_store_dwordx4 v[192:195], v27, s[60:63], s77 offen sc1
    s_add_u32 s77, s77, 4096
    buffer_store_dwordx4 v[196:199], v27, s[60:63], s77 offen sc1
    s_waitcnt vmcnt(37)
    ds_read_b128 a[0:3], v10 offset:0
    ds_read_b128 a[4:7], v11 offset:0
    ds_read_b128 a[64:67], v10 offset:8192
    ds_read_b128 a[68:71], v11 offset:8192
    ds_read_b128 a[8:11], v10 offset:2048
    ds_read_b128 a[12:15], v11 offset:2048
    ds_read_b128 a[72:75], v10 offset:10240
    ds_read_b128 a[76:79], v11 offset:10240
    ds_read_b128 a[16:19], v10 offset:4096
    ds_read_b128 a[20:23], v11 offset:4096
    ds_read_b128 a[80:83], v10 offset:12288
    ds_read_b128 a[84:87], v11 offset:12288
    ds_read_b128 a[24:27], v10 offset:6144
    ds_read_b128 a[28:31], v11 offset:6144
    ds_read_b128 a[88:91], v10 offset:14336
    ds_read_b128 a[92:95], v11 offset:14336
    s_waitcnt vmcnt(9) lgkmcnt(0)
    s_barrier
    ds_read_b64 v[216:217], v200 offset:0
    ds_read_b64 v[218:219], v200 offset:2048
    ds_read_b64 v[220:221], v200 offset:4096
    ds_read_b64 v[222:223], v200 offset:6144
    ds_read_b128 v[108:111], v8 offset:0
    ds_read_b128 v[112:115], v8 offset:2048
    ds_read_b128 v[116:119], v8 offset:4096
    ds_read_b128 v[120:123], v8 offset:6144
    ds_read_b128 v[124:127], v9 offset:0
    ds_read_b128 v[128:131], v9 offset:2048
    ds_read_b128 v[132:135], v9 offset:4096
    ds_read_b128 v[136:139], v9 offset:6144
    s_waitcnt lgkmcnt(4)
    v_mfma_f32_16x16x32_bf16 v[64:67], v[108:111], a[0:3], 0
    v_lshrrev_b32 v36, 3, v1
    v_mfma_f32_16x16x32_bf16 v[68:71], v[112:115], a[0:3], 0
    v_and_b32 v38, 7, v1
    v_mfma_f32_16x16x32_bf16 v[72:75], v[116:119], a[0:3], 0
    s_add_u32 m0, s79, 0
    s_xor_b32 s5, s34, 512
    buffer_load_dwordx4 v6, s[44:47], s5 offen lds
    v_mfma_f32_16x16x32_bf16 v[76:79], v[120:123], a[0:3], 0
    v_xor_b32 v37, v3, v38
    v_mfma_f32_16x16x32_bf16 v[96:99], v[104:107], a[0:3], 0
    v_lshlrev_b32 v37, 4, v37
    v_mfma_f32_16x16x32_bf16 v[80:83], v[108:111], a[64:67], 0
    buffer_load_dwordx4 v7, s[44:47], s5 offen offset:1024 lds
    v_mfma_f32_16x16x32_bf16 v[84:87], v[112:115], a[64:67], 0
    v_lshl_add_u32 v14, v36, 10, v37
    v_mfma_f32_16x16x32_bf16 v[88:91], v[116:119], a[64:67], 0
    v_xor_b32 v15, 64, v14
    v_mfma_f32_16x16x32_bf16 v[92:95], v[120:123], a[64:67], 0
    s_add_u32 m0, s79, 8192
    s_nop 0
    buffer_load_dwordx4 v6, s[48:51], s5 offen lds
    v_mfma_f32_16x16x32_bf16 v[100:103], v[104:107], a[64:67], 0
    v_add_u32 v15, 7168, v15
    ds_read_b128 v[108:111], v8 offset:8192
    ds_read_b128 v[112:115], v8 offset:10240
    ds_read_b128 v[116:119], v8 offset:12288
    ds_read_b128 v[120:123], v8 offset:14336
    s_waitcnt lgkmcnt(4)
    v_mfma_f32_16x16x32_bf16 v[64:67], v[124:127], a[4:7], v[64:67]
    s_lshl_b32 s14, s74, 16
    s_and_b32 s77, s72, 1
    s_lshl_b32 s77, s77, 9
    s_add_u32 s14, s14, s77
    v_mfma_f32_16x16x32_bf16 v[68:71], v[128:131], a[4:7], v[68:71]
    buffer_load_dwordx4 v7, s[48:51], s5 offen offset:1024 lds
    v_mfma_f32_16x16x32_bf16 v[72:75], v[132:135], a[4:7], v[72:75]
    v_lshlrev_b32 v36, 4, v2
    v_mfma_f32_16x16x32_bf16 v[76:79], v[136:139], a[4:7], v[76:79]
    v_lshl_add_u32 v16, v3, 13, v36
    v_mfma_f32_16x16x32_bf16 v[96:99], v[104:107], a[4:7], v[96:99]
    s_add_u32 m0, s79, 2048
    s_xor_b32 s5, s34, 640
    buffer_load_dwordx4 v6, s[44:47], s5 offen lds
    v_mfma_f32_16x16x32_bf16 v[80:83], v[124:127], a[68:71], v[80:83]
    v_mov_b32 v37, 22272
    v_mfma_f32_16x16x32_bf16 v[84:87], v[128:131], a[68:71], v[84:87]
    v_mad_u32_u24 v17, v3, v37, v36
    v_mfma_f32_16x16x32_bf16 v[88:91], v[132:135], a[68:71], v[88:91]
    buffer_load_dwordx4 v7, s[44:47], s5 offen offset:1024 lds
    v_mfma_f32_16x16x32_bf16 v[92:95], v[136:139], a[68:71], v[92:95]
    v_lshlrev_b32 v18, 7, v0
    s_cmp_eq_u32 s75, 28
    s_cselect_b32 s77, 1, 2
    s_lshl_b32 s77, s77, 8
    v_add_u32 v239, s77, v17
    v_mfma_f32_16x16x32_bf16 v[100:103], v[104:107], a[68:71], v[100:103]
    v_lshlrev_b32 v19, 2, v1
    ds_read_b128 v[124:127], v9 offset:8192
    ds_read_b128 v[128:131], v9 offset:10240
    ds_read_b128 v[132:135], v9 offset:12288
    ds_read_b128 v[136:139], v9 offset:14336
    s_waitcnt lgkmcnt(4)
    v_mfma_f32_16x16x32_bf16 v[64:67], v[108:111], a[8:11], v[64:67]
    s_add_u32 m0, s79, 10240
    s_nop 0
    buffer_load_dwordx4 v6, s[48:51], s5 offen lds
    v_mfma_f32_16x16x32_bf16 v[68:71], v[112:115], a[8:11], v[68:71]
    v_add_u32 v19, s12, v19
    v_mfma_f32_16x16x32_bf16 v[72:75], v[116:119], a[8:11], v[72:75]
    v_lshlrev_b32 v20, 6, v3
    v_mfma_f32_16x16x32_bf16 v[76:79], v[120:123], a[8:11], v[76:79]
    buffer_load_dwordx4 v7, s[48:51], s5 offen offset:1024 lds
    v_mfma_f32_16x16x32_bf16 v[96:99], v[104:107], a[8:11], v[96:99]
    v_add_u32 v20, s12, v20
    v_mfma_f32_16x16x32_bf16 v[80:83], v[108:111], a[72:75], v[80:83]
    s_lshl_b32 s77, s72, 6
    s_add_u32 s77, s77, s12
    v_lshlrev_b32 v21, 2, v3
    v_add_u32 v21, s77, v21
    v_mfma_f32_16x16x32_bf16 v[84:87], v[112:115], a[72:75], v[84:87]
    s_add_u32 m0, s79, 4096
    s_xor_b32 s5, s34, 768
    buffer_load_dwordx4 v6, s[44:47], s5 offen lds
    v_mfma_f32_16x16x32_bf16 v[88:91], v[116:119], a[72:75], v[88:91]
    s_lshl_b32 s21, s73, 10
    s_add_u32 s21, s21, 65536
    v_mfma_f32_16x16x32_bf16 v[92:95], v[120:123], a[72:75], v[92:95]
    v_lshlrev_b32 v24, 16, v24
    v_mfma_f32_16x16x32_bf16 v[100:103], v[104:107], a[72:75], v[100:103]
    buffer_load_dwordx4 v7, s[44:47], s5 offen offset:1024 lds
    ds_read_b128 v[108:111], v8 offset:16384
    ds_read_b128 v[112:115], v8 offset:18432
    ds_read_b128 v[116:119], v8 offset:20480
    ds_read_b128 v[120:123], v8 offset:22528
    s_waitcnt lgkmcnt(4)
    v_mfma_f32_16x16x32_bf16 v[64:67], v[124:127], a[12:15], v[64:67]
    v_lshlrev_b32 v25, 16, v25
    v_mfma_f32_16x16x32_bf16 v[68:71], v[128:131], a[12:15], v[68:71]
    v_lshlrev_b32 v26, 16, v26
    v_mfma_f32_16x16x32_bf16 v[72:75], v[132:135], a[12:15], v[72:75]
    s_add_u32 m0, s79, 12288
    s_nop 0
    buffer_load_dwordx4 v6, s[48:51], s5 offen lds
    v_mfma_f32_16x16x32_bf16 v[76:79], v[136:139], a[12:15], v[76:79]
    v_mul_f32 v26, 0x3fb8aa3b, v26
    v_mfma_f32_16x16x32_bf16 v[96:99], v[104:107], a[12:15], v[96:99]
    v_exp_f32 v26, v26
    v_mfma_f32_16x16x32_bf16 v[80:83], v[124:127], a[76:79], v[80:83]
    buffer_load_dwordx4 v7, s[48:51], s5 offen offset:1024 lds
    v_mfma_f32_16x16x32_bf16 v[84:87], v[128:131], a[76:79], v[84:87]
    v_cvt_pk_bf16_f32 v26, v26, v26
    v_mfma_f32_16x16x32_bf16 v[88:91], v[132:135], a[76:79], v[88:91]
    v_lshlrev_b32 v26, 16, v26
    v_mfma_f32_16x16x32_bf16 v[92:95], v[136:139], a[76:79], v[92:95]
    s_add_u32 m0, s79, 6144
    s_xor_b32 s5, s34, 896
    buffer_load_dwordx4 v6, s[44:47], s5 offen lds
    v_mfma_f32_16x16x32_bf16 v[100:103], v[104:107], a[76:79], v[100:103]
    v_mul_f32 v32, v26, v24
    s_waitcnt vmcnt(13)
    s_barrier
    s_cmp_lg_u32 s72, 0
    s_cbranch_scc1 kf1
    s_lshl_b32 s77, s22, 7
    v_mov_b32 v30, 0
    s_mov_b64 exec, 1
    buffer_store_dword v236, v30, s[64:67], s77 offen offset:0 sc1
    s_mov_b64 exec, -1
kf1:
    ds_read_b128 v[124:127], v9 offset:16384
    ds_read_b128 v[128:131], v9 offset:18432
    ds_read_b128 v[132:135], v9 offset:20480
    ds_read_b128 v[136:139], v9 offset:22528
    s_waitcnt lgkmcnt(4)
    v_mfma_f32_16x16x32_bf16 v[64:67], v[108:111], a[16:19], v[64:67]
    v_mul_f32 v33, v26, v25
    v_mfma_f32_16x16x32_bf16 v[68:71], v[112:115], a[16:19], v[68:71]
    buffer_load_dwordx4 v7, s[44:47], s5 offen offset:1024 lds
    v_mfma_f32_16x16x32_bf16 v[72:75], v[116:119], a[16:19], v[72:75]
    v_mul_f32 v32, 0x3fb8aa3b, v32
    v_mfma_f32_16x16x32_bf16 v[76:79], v[120:123], a[16:19], v[76:79]
    v_mul_f32 v33, 0.15915494309189535, v33
    v_mfma_f32_16x16x32_bf16 v[96:99], v[104:107], a[16:19], v[96:99]
    s_add_u32 m0, s79, 14336
    s_nop 0
    buffer_load_dwordx4 v6, s[48:51], s5 offen lds
    v_mfma_f32_16x16x32_bf16 v[80:83], v[108:111], a[80:83], v[80:83]
    v_exp_f32 v32, v32
    v_mfma_f32_16x16x32_bf16 v[84:87], v[112:115], a[80:83], v[84:87]
    v_rndne_f32 v34, v33
    v_mfma_f32_16x16x32_bf16 v[88:91], v[116:119], a[80:83], v[88:91]
    buffer_load_dwordx4 v7, s[48:51], s5 offen offset:1024 lds
    v_mfma_f32_16x16x32_bf16 v[92:95], v[120:123], a[80:83], v[92:95]
    v_sub_f32 v33, v33, v34
    v_mfma_f32_16x16x32_bf16 v[100:103], v[104:107], a[80:83], v[100:103]
    v_cos_f32 v34, v33
    ds_read_b128 v[108:111], v8 offset:24576
    ds_read_b128 v[112:115], v8 offset:26624
    ds_read_b128 v[116:119], v8 offset:28672
    ds_read_b128 v[120:123], v8 offset:30720
    s_waitcnt lgkmcnt(4)
    v_mfma_f32_16x16x32_bf16 v[64:67], v[124:127], a[20:23], v[64:67]
    s_mul_i32 s3, s22, 22016
    s_mul_i32 s5, s72, 5504
    s_add_u32 s3, s3, s5
    v_min_u32 v249, 42, v1
    v_lshlrev_b32 v249, 7, v249
    v_add_u32 v249, s3, v249
    global_load_dword v250, v249, s[28:29]
    v_mfma_f32_16x16x32_bf16 v[68:71], v[128:131], a[20:23], v[68:71]
    v_sin_f32 v35, v33
    v_mfma_f32_16x16x32_bf16 v[72:75], v[132:135], a[20:23], v[72:75]
    v_mul_f32 v204, v32, v34
    v_mfma_f32_16x16x32_bf16 v[76:79], v[136:139], a[20:23], v[76:79]
    v_mul_f32 v205, v32, v35
    v_mfma_f32_16x16x32_bf16 v[96:99], v[104:107], a[20:23], v[96:99]
    v_mul_f32 v36, v24, v24
    v_mfma_f32_16x16x32_bf16 v[80:83], v[124:127], a[84:87], v[80:83]
    v_fmac_f32 v36, v25, v25
    v_mfma_f32_16x16x32_bf16 v[84:87], v[128:131], a[84:87], v[84:87]
    v_rcp_f32 v36, v36
    v_mfma_f32_16x16x32_bf16 v[88:91], v[132:135], a[84:87], v[88:91]
    v_add_f32 v37, -1.0, v204
    v_mfma_f32_16x16x32_bf16 v[92:95], v[136:139], a[84:87], v[92:95]
    v_mul_f32 v38, v37, v24
    v_mfma_f32_16x16x32_bf16 v[100:103], v[104:107], a[84:87], v[100:103]
    v_fmac_f32 v38, v205, v25
    ds_read_b128 v[124:127], v9 offset:24576
    ds_read_b128 v[128:131], v9 offset:26624
    ds_read_b128 v[132:135], v9 offset:28672
    ds_read_b128 v[136:139], v9 offset:30720
    s_waitcnt lgkmcnt(4)
    v_mfma_f32_16x16x32_bf16 v[64:67], v[108:111], a[24:27], v[64:67]
    v_mul_f32 v39, v205, v24
    v_mfma_f32_16x16x32_bf16 v[68:71], v[112:115], a[24:27], v[68:71]
    v_fma_f32 v39, -v37, v25, v39
    v_mfma_f32_16x16x32_bf16 v[72:75], v[116:119], a[24:27], v[72:75]
    v_add_f32 v36, v36, v36
    v_mfma_f32_16x16x32_bf16 v[76:79], v[120:123], a[24:27], v[76:79]
    v_mul_f32 v206, v38, v36
    v_mfma_f32_16x16x32_bf16 v[96:99], v[104:107], a[24:27], v[96:99]
    v_mul_f32 v207, v39, v36
    v_mfma_f32_16x16x32_bf16 v[80:83], v[108:111], a[88:91], v[80:83]
    v_mul_f32 v32, v204, v204
    v_mfma_f32_16x16x32_bf16 v[84:87], v[112:115], a[88:91], v[84:87]
    v_add_f32 v33, v204, v204
    v_mfma_f32_16x16x32_bf16 v[88:91], v[116:119], a[88:91], v[88:91]
    v_fma_f32 v32, -v205, v205, v32
    v_mfma_f32_16x16x32_bf16 v[92:95], v[120:123], a[88:91], v[92:95]
    v_mul_f32 v33, v33, v205
    v_mfma_f32_16x16x32_bf16 v[100:103], v[104:107], a[88:91], v[100:103]
    v_mul_f32 v34, v32, v32
    ds_read_b128 v[108:111], v8 offset:32768
    ds_read_b128 v[112:115], v8 offset:34816
    ds_read_b128 v[116:119], v8 offset:36864
    ds_read_b128 v[120:123], v8 offset:38912
    s_waitcnt lgkmcnt(4)
    v_mfma_f32_16x16x32_bf16 v[64:67], v[124:127], a[28:31], v[64:67]
    v_add_f32 v35, v32, v32
    v_mfma_f32_16x16x32_bf16 v[68:71], v[128:131], a[28:31], v[68:71]
    v_fma_f32 v34, -v33, v33, v34
    v_mfma_f32_16x16x32_bf16 v[72:75], v[132:135], a[28:31], v[72:75]
    v_mul_f32 v35, v35, v33
    v_mfma_f32_16x16x32_bf16 v[76:79], v[136:139], a[28:31], v[76:79]
    v_mul_f32 v32, v34, v34
    v_mfma_f32_16x16x32_bf16 v[96:99], v[104:107], a[28:31], v[96:99]
    v_add_f32 v33, v34, v34
    v_mfma_f32_16x16x32_bf16 v[80:83], v[124:127], a[92:95], v[80:83]
    v_fma_f32 v32, -v35, v35, v32
    v_mfma_f32_16x16x32_bf16 v[84:87], v[128:131], a[92:95], v[84:87]
    v_mul_f32 v33, v33, v35
    v_mfma_f32_16x16x32_bf16 v[88:91], v[132:135], a[92:95], v[88:91]
    v_mul_f32 v208, v32, v32
    v_mfma_f32_16x16x32_bf16 v[92:95], v[136:139], a[92:95], v[92:95]
    v_add_f32 v209, v32, v32
    v_mfma_f32_16x16x32_bf16 v[100:103], v[104:107], a[92:95], v[100:103]
    v_fma_f32 v208, -v33, v33, v208
    s_waitcnt vmcnt(1)
    ds_read_b128 a[32:35], v10 offset:0
    ds_read_b128 a[36:39], v11 offset:0
    ds_read_b128 a[96:99], v10 offset:8192
    ds_read_b128 a[100:103], v11 offset:8192
    ds_read_b128 a[40:43], v10 offset:2048
    ds_read_b128 a[44:47], v11 offset:2048
    ds_read_b128 a[104:107], v10 offset:10240
    ds_read_b128 a[108:111], v11 offset:10240
    ds_read_b128 a[48:51], v10 offset:4096
    ds_read_b128 a[52:55], v11 offset:4096
    ds_read_b128 a[112:115], v10 offset:12288
    ds_read_b128 a[116:119], v11 offset:12288
    ds_read_b128 a[56:59], v10 offset:6144
    ds_read_b128 a[60:63], v11 offset:6144
    ds_read_b128 a[120:123], v10 offset:14336
    ds_read_b128 a[124:127], v11 offset:14336
    s_waitcnt lgkmcnt(0)
    s_barrier
    ds_read_b128 v[124:127], v9 offset:32768
    ds_read_b128 v[128:131], v9 offset:34816
    ds_read_b128 v[132:135], v9 offset:36864
    ds_read_b128 v[136:139], v9 offset:38912
    v_mfma_f32_16x16x32_bf16 v[64:67], v[108:111], a[32:35], v[64:67]
    v_mul_f32 v209, v209, v33
    v_mfma_f32_16x16x32_bf16 v[68:71], v[112:115], a[32:35], v[68:71]
    v_mul_f32 v32, v208, v208
    v_mfma_f32_16x16x32_bf16 v[72:75], v[116:119], a[32:35], v[72:75]
    v_add_f32 v33, v208, v208
    v_mfma_f32_16x16x32_bf16 v[76:79], v[120:123], a[32:35], v[76:79]
    s_add_u32 m0, s24, 0
    s_add_u32 s5, s14, 0
    buffer_load_dwordx4 v14, s[68:71], s5 offen lds
    v_mfma_f32_16x16x32_bf16 v[96:99], v[104:107], a[32:35], v[96:99]
    v_fma_f32 v32, -v209, v209, v32
    v_mfma_f32_16x16x32_bf16 v[80:83], v[108:111], a[96:99], v[80:83]
    v_mul_f32 v33, v33, v209
    v_mfma_f32_16x16x32_bf16 v[84:87], v[112:115], a[96:99], v[84:87]
    v_mul_f32 v210, v32, v32
    v_mfma_f32_16x16x32_bf16 v[88:91], v[116:119], a[96:99], v[88:91]
    buffer_load_dwordx4 v15, s[68:71], s5 offen offset:1024 lds
    v_mfma_f32_16x16x32_bf16 v[92:95], v[120:123], a[96:99], v[92:95]
    v_add_f32 v211, v32, v32
    v_mfma_f32_16x16x32_bf16 v[100:103], v[104:107], a[96:99], v[100:103]
    v_fma_f32 v210, -v33, v33, v210
    ds_read_b128 v[108:111], v8 offset:40960
    ds_read_b128 v[112:115], v8 offset:43008
    ds_read_b128 v[116:119], v8 offset:45056
    ds_read_b128 v[120:123], v8 offset:47104
    s_waitcnt lgkmcnt(4)
    v_mfma_f32_16x16x32_bf16 v[64:67], v[124:127], a[36:39], v[64:67]
    v_mul_f32 v211, v211, v33
    v_mfma_f32_16x16x32_bf16 v[68:71], v[128:131], a[36:39], v[68:71]
    s_add_u32 m0, s24, 2048
    s_add_u32 s5, s14, 16384
    buffer_load_dwordx4 v14, s[68:71], s5 offen lds
    v_mfma_f32_16x16x32_bf16 v[72:75], v[132:135], a[36:39], v[72:75]
    v_mul_f32 v32, v210, v210
    v_mfma_f32_16x16x32_bf16 v[76:79], v[136:139], a[36:39], v[76:79]
    v_add_f32 v33, v210, v210
    v_mfma_f32_16x16x32_bf16 v[96:99], v[104:107], a[36:39], v[96:99]
    v_fma_f32 v32, -v211, v211, v32
    v_mfma_f32_16x16x32_bf16 v[80:83], v[124:127], a[100:103], v[80:83]
    buffer_load_dwordx4 v15, s[68:71], s5 offen offset:1024 lds
    v_mfma_f32_16x16x32_bf16 v[84:87], v[128:131], a[100:103], v[84:87]
    v_mul_f32 v33, v33, v211
    v_mfma_f32_16x16x32_bf16 v[88:91], v[132:135], a[100:103], v[88:91]
    v_mul_f32 v34, v32, v32
    v_mfma_f32_16x16x32_bf16 v[92:95], v[136:139], a[100:103], v[92:95]
    v_add_f32 v35, v32, v32
    v_mfma_f32_16x16x32_bf16 v[100:103], v[104:107], a[100:103], v[100:103]
    s_add_u32 m0, s24, 4096
    s_add_u32 s5, s14, 32768
    buffer_load_dwordx4 v14, s[68:71], s5 offen lds
    ds_read_b128 v[124:127], v9 offset:40960
    ds_read_b128 v[128:131], v9 offset:43008
    ds_read_b128 v[132:135], v9 offset:45056
    ds_read_b128 v[136:139], v9 offset:47104
    s_waitcnt lgkmcnt(4)
    v_mfma_f32_16x16x32_bf16 v[64:67], v[108:111], a[40:43], v[64:67]
    v_fma_f32 v34, -v33, v33, v34
    v_mfma_f32_16x16x32_bf16 v[68:71], v[112:115], a[40:43], v[68:71]
    v_mul_f32 v35, v35, v33
    v_mfma_f32_16x16x32_bf16 v[72:75], v[116:119], a[40:43], v[72:75]
    v_mul_f32 v212, v34, v34
    v_mfma_f32_16x16x32_bf16 v[76:79], v[120:123], a[40:43], v[76:79]
    buffer_load_dwordx4 v15, s[68:71], s5 offen offset:1024 lds
    v_mfma_f32_16x16x32_bf16 v[96:99], v[104:107], a[40:43], v[96:99]
    v_add_f32 v213, v34, v34
    v_mfma_f32_16x16x32_bf16 v[80:83], v[108:111], a[104:107], v[80:83]
    v_fma_f32 v212, -v35, v35, v212
    v_mfma_f32_16x16x32_bf16 v[84:87], v[112:115], a[104:107], v[84:87]
    v_mul_f32 v213, v213, v35
    v_mfma_f32_16x16x32_bf16 v[88:91], v[116:119], a[104:107], v[88:91]
    s_add_u32 m0, s24, 6144
    s_add_u32 s5, s14, 49152
    buffer_load_dwordx4 v14, s[68:71], s5 offen lds
    v_mfma_f32_16x16x32_bf16 v[92:95], v[120:123], a[104:107], v[92:95]
    s_lshl_b32 s77, s74, 2
    s_add_u32 s15, s77, s72
    s_lshl_b32 s77, s15, 13
    s_add_u32 s77, s77, 14680064
    s_add_u32 s40, s36, s77
    s_addc_u32 s41, s37, 0
    s_and_b32 s41, s41, 0xffff
    s_mov_b32 s42, 8192
    v_mfma_f32_16x16x32_bf16 v[100:103], v[104:107], a[104:107], v[100:103]
    s_add_u32 s60, s36, 2097152
    s_addc_u32 s61, s37, 0
    s_and_b32 s61, s61, 0xffff
    s_mov_b32 s62, 5701632
    s_mov_b32 s63, 0x20000
    ds_read_b128 v[108:111], v8 offset:49152
    ds_read_b128 v[112:115], v8 offset:51200
    ds_read_b128 v[116:119], v8 offset:53248
    ds_read_b128 v[120:123], v8 offset:55296
    s_waitcnt lgkmcnt(4)
    v_mfma_f32_16x16x32_bf16 v[64:67], v[124:127], a[44:47], v[64:67]
    s_cmp_lt_u32 s2, 232
    s_cselect_b32 s58, 2097152, 0
    s_cselect_b32 s62, 5701632, 0
    v_mfma_f32_16x16x32_bf16 v[68:71], v[128:131], a[44:47], v[68:71]
    buffer_load_dwordx4 v15, s[68:71], s5 offen offset:1024 lds
    v_mfma_f32_16x16x32_bf16 v[72:75], v[132:135], a[44:47], v[72:75]
    s_lshl_b32 s16, s72, 19
    s_lshl_b32 s77, s76, 10
    s_add_u32 s16, s16, s77
    v_mfma_f32_16x16x32_bf16 v[76:79], v[136:139], a[44:47], v[76:79]
    s_mul_i32 s17, s72, 1425408
    s_mul_i32 s77, s75, 768
    s_add_u32 s17, s17, s77
    v_mfma_f32_16x16x32_bf16 v[96:99], v[104:107], a[44:47], v[96:99]
    s_mul_i32 s77, s75, 0
    s_mul_i32 vcc_lo, s76, 0
    s_add_u32 s77, s77, vcc_lo
    s_and_b32 s77, s77, 15
    s_lshl_b32 vcc_lo, s77, 15
    s_add_u32 s16, s16, vcc_lo
    s_mul_i32 s77, s77, 89088
    s_add_u32 s17, s17, s77
    v_mfma_f32_16x16x32_bf16 v[80:83], v[124:127], a[108:111], v[80:83]
    s_add_u32 m0, s24, 8192
    s_add_u32 s5, s14, 256
    buffer_load_dwordx4 v14, s[68:71], s5 offen lds
    v_mfma_f32_16x16x32_bf16 v[84:87], v[128:131], a[108:111], v[84:87]
    v_mfma_f32_16x16x32_bf16 v[88:91], v[132:135], a[108:111], v[88:91]
    v_mfma_f32_16x16x32_bf16 v[92:95], v[136:139], a[108:111], v[92:95]
    v_mfma_f32_16x16x32_bf16 v[100:103], v[104:107], a[108:111], v[100:103]
    buffer_load_dwordx4 v15, s[68:71], s5 offen offset:1024 lds
    ds_read_b128 v[124:127], v9 offset:49152
    ds_read_b128 v[128:131], v9 offset:51200
    ds_read_b128 v[132:135], v9 offset:53248
    ds_read_b128 v[136:139], v9 offset:55296
    s_waitcnt lgkmcnt(4)
    buffer_load_dwordx4 v[176:179], v27, s[64:67], s21 offen sc1
    v_mfma_f32_16x16x32_bf16 v[64:67], v[108:111], a[48:51], v[64:67]
    v_mfma_f32_16x16x32_bf16 v[68:71], v[112:115], a[48:51], v[68:71]
    v_mfma_f32_16x16x32_bf16 v[72:75], v[116:119], a[48:51], v[72:75]
    v_mfma_f32_16x16x32_bf16 v[76:79], v[120:123], a[48:51], v[76:79]
    s_add_u32 m0, s24, 10240
    s_add_u32 s5, s14, 16640
    buffer_load_dwordx4 v14, s[68:71], s5 offen lds
    v_mfma_f32_16x16x32_bf16 v[96:99], v[104:107], a[48:51], v[96:99]
    v_mfma_f32_16x16x32_bf16 v[80:83], v[108:111], a[112:115], v[80:83]
    v_mfma_f32_16x16x32_bf16 v[84:87], v[112:115], a[112:115], v[84:87]
    v_mfma_f32_16x16x32_bf16 v[88:91], v[116:119], a[112:115], v[88:91]
    buffer_load_dwordx4 v15, s[68:71], s5 offen offset:1024 lds
    v_mfma_f32_16x16x32_bf16 v[92:95], v[120:123], a[112:115], v[92:95]
    v_mfma_f32_16x16x32_bf16 v[100:103], v[104:107], a[112:115], v[100:103]
    ds_read_b128 v[108:111], v8 offset:57344
    ds_read_b128 v[112:115], v8 offset:59392
    ds_read_b128 v[116:119], v8 offset:61440
    ds_read_b128 v[120:123], v8 offset:63488
    s_waitcnt lgkmcnt(4)
    v_mfma_f32_16x16x32_bf16 v[64:67], v[124:127], a[52:55], v[64:67]
    v_mfma_f32_16x16x32_bf16 v[68:71], v[128:131], a[52:55], v[68:71]
    s_add_u32 m0, s24, 12288
    s_add_u32 s5, s14, 33024
    buffer_load_dwordx4 v14, s[68:71], s5 offen lds
    v_mfma_f32_16x16x32_bf16 v[72:75], v[132:135], a[52:55], v[72:75]
    v_mfma_f32_16x16x32_bf16 v[76:79], v[136:139], a[52:55], v[76:79]
    v_mfma_f32_16x16x32_bf16 v[96:99], v[104:107], a[52:55], v[96:99]
    v_mfma_f32_16x16x32_bf16 v[80:83], v[124:127], a[116:119], v[80:83]
    buffer_load_dwordx4 v15, s[68:71], s5 offen offset:1024 lds
    v_mfma_f32_16x16x32_bf16 v[84:87], v[128:131], a[116:119], v[84:87]
    v_mfma_f32_16x16x32_bf16 v[88:91], v[132:135], a[116:119], v[88:91]
    v_mfma_f32_16x16x32_bf16 v[92:95], v[136:139], a[116:119], v[92:95]
    v_mfma_f32_16x16x32_bf16 v[100:103], v[104:107], a[116:119], v[100:103]
    s_add_u32 m0, s24, 14336
    s_add_u32 s5, s14, 49408
    buffer_load_dwordx4 v14, s[68:71], s5 offen lds
    ds_read_b128 v[124:127], v9 offset:57344
    ds_read_b128 v[128:131], v9 offset:59392
    ds_read_b128 v[132:135], v9 offset:61440
    ds_read_b128 v[136:139], v9 offset:63488
    s_waitcnt lgkmcnt(4)
    buffer_load_dword v238, v18, s[64:67], 0 offen offset:0 sc1
    v_mfma_f32_16x16x32_bf16 v[64:67], v[108:111], a[56:59], v[64:67]
    v_mfma_f32_16x16x32_bf16 v[68:71], v[112:115], a[56:59], v[68:71]
    v_mfma_f32_16x16x32_bf16 v[72:75], v[116:119], a[56:59], v[72:75]
    v_mfma_f32_16x16x32_bf16 v[76:79], v[120:123], a[56:59], v[76:79]
    buffer_load_dwordx4 v15, s[68:71], s5 offen offset:1024 lds
    v_mfma_f32_16x16x32_bf16 v[96:99], v[104:107], a[56:59], v[96:99]
    v_mfma_f32_16x16x32_bf16 v[80:83], v[108:111], a[120:123], v[80:83]
    v_mfma_f32_16x16x32_bf16 v[84:87], v[112:115], a[120:123], v[84:87]
    v_mfma_f32_16x16x32_bf16 v[88:91], v[116:119], a[120:123], v[88:91]
    s_add_u32 m0, s24, 16384
    s_add_u32 s5, s14, 384
    buffer_load_dwordx4 v14, s[68:71], s5 offen lds
    v_mfma_f32_16x16x32_bf16 v[92:95], v[120:123], a[120:123], v[92:95]
    v_mfma_f32_16x16x32_bf16 v[100:103], v[104:107], a[120:123], v[100:103]
    s_waitcnt lgkmcnt(0)
    v_mfma_f32_16x16x32_bf16 v[64:67], v[124:127], a[60:63], v[64:67]
    v_mfma_f32_16x16x32_bf16 v[68:71], v[128:131], a[60:63], v[68:71]
    buffer_load_dwordx4 v15, s[68:71], s5 offen offset:1024 lds
    v_mfma_f32_16x16x32_bf16 v[72:75], v[132:135], a[60:63], v[72:75]
    v_mfma_f32_16x16x32_bf16 v[76:79], v[136:139], a[60:63], v[76:79]
    v_mfma_f32_16x16x32_bf16 v[96:99], v[104:107], a[60:63], v[96:99]
    v_mfma_f32_16x16x32_bf16 v[80:83], v[124:127], a[124:127], v[80:83]
    s_add_u32 m0, s24, 18432
    s_add_u32 s5, s14, 16768
    buffer_load_dwordx4 v14, s[68:71], s5 offen lds
    v_mfma_f32_16x16x32_bf16 v[84:87], v[128:131], a[124:127], v[84:87]
    v_mfma_f32_16x16x32_bf16 v[88:91], v[132:135], a[124:127], v[88:91]
    v_mfma_f32_16x16x32_bf16 v[92:95], v[136:139], a[124:127], v[92:95]
    v_mfma_f32_16x16x32_bf16 v[100:103], v[104:107], a[124:127], v[100:103]
    buffer_load_dwordx4 v15, s[68:71], s5 offen offset:1024 lds
    s_waitcnt vmcnt(11)
    v_cmp_ne_u32 s[6:7], v178, v236
    s_nop 1
    s_cmp_eq_u64 s[6:7], 0
    s_cbranch_scc1 kp0_ok
    s_mov_b32 s3, 0
kp0_lp:
    s_sleep 1
    buffer_load_dwordx4 v[176:179], v27, s[64:67], s21 offen sc1
    s_waitcnt vmcnt(0)
    v_cmp_ne_u32 s[6:7], v178, v236
    s_add_u32 s3, s3, 1
    s_nop 0
    s_cmp_eq_u64 s[6:7], 0
    s_cbranch_scc1 kp0_ok
    s_cmp_lt_u32 s3, 200000
    s_cbranch_scc1 kp0_lp
kp0_ok:
    ds_write_b32 v19, v176
    ds_write_b32 v19, v177 offset:256
    ds_read_b128 v[140:143], v20 offset:0
    ds_read_b128 v[156:159], v20 offset:256
    ds_read_b128 v[144:147], v20 offset:16
    ds_read_b128 v[160:163], v20 offset:272
    ds_read_b128 v[148:151], v20 offset:32
    ds_read_b128 v[164:167], v20 offset:288
    ds_read_b128 v[152:155], v20 offset:48
    ds_read_b128 v[168:171], v20 offset:304
    ds_read2_b32 v[240:241], v21 offset0:0 offset1:4
    ds_read2_b32 v[244:245], v21 offset0:64 offset1:68
    ds_read2_b32 v[242:243], v21 offset0:8 offset1:12
    ds_read2_b32 v[246:247], v21 offset0:72 offset1:76
    v_mul_f32 v32, v206, v96
    v_mul_f32 v33, v206, v100
    v_fma_f32 v32, -v207, v100, v32
    v_fma_f32 v33, v207, v96, v33
    s_add_u32 m0, s24, 20480
    s_add_u32 s5, s14, 33152
    buffer_load_dwordx4 v14, s[68:71], s5 offen lds
    buffer_load_dwordx4 v15, s[68:71], s5 offen offset:1024 lds
    s_add_u32 m0, s24, 22528
    s_add_u32 s5, s14, 49536
    buffer_load_dwordx4 v14, s[68:71], s5 offen lds
    buffer_load_dwordx4 v15, s[68:71], s5 offen offset:1024 lds
    s_waitcnt lgkmcnt(0)
    v_mul_f32 v36, v206, v64
    v_mul_f32 v37, v206, v80
    v_fma_f32 v36, -v207, v80, v36
    v_fma_f32 v37, v207, v64, v37
    v_fma_f32 v36, -v140, v32, v36
    v_fma_f32 v37, -v140, v33, v37
    v_mul_f32 v64, v156, v36
    v_mul_f32 v80, v156, v37
    v_mul_f32 v38, v206, v65
    v_mul_f32 v39, v206, v81
    v_fma_f32 v38, -v207, v81, v38
    v_fma_f32 v39, v207, v65, v39
    v_fma_f32 v38, -v141, v32, v38
    v_fma_f32 v39, -v141, v33, v39
    v_mul_f32 v38, v157, v38
    v_mul_f32 v39, v157, v39
    v_fma_f32 v38, -v205, v80, v38
    v_fma_f32 v39, v205, v64, v39
    v_fma_f32 v65, v204, v64, v38
    v_fma_f32 v81, v204, v80, v39
    v_mul_f32 v36, v206, v66
    v_mul_f32 v37, v206, v82
    v_fma_f32 v36, -v207, v82, v36
    v_fma_f32 v37, v207, v66, v37
    v_fma_f32 v36, -v142, v32, v36
    v_fma_f32 v37, -v142, v33, v37
    v_mul_f32 v36, v158, v36
    v_mul_f32 v37, v158, v37
    v_fma_f32 v36, -v205, v81, v36
    v_fma_f32 v37, v205, v65, v37
    v_fma_f32 v66, v204, v65, v36
    v_fma_f32 v82, v204, v81, v37
    v_mul_f32 v38, v206, v67
    v_mul_f32 v39, v206, v83
    v_fma_f32 v38, -v207, v83, v38
    v_fma_f32 v39, v207, v67, v39
    v_fma_f32 v38, -v143, v32, v38
    v_fma_f32 v39, -v143, v33, v39
    v_mul_f32 v38, v159, v38
    v_mul_f32 v39, v159, v39
    v_fma_f32 v38, -v205, v82, v38
    v_fma_f32 v39, v205, v66, v39
    v_fma_f32 v67, v204, v66, v38
    v_fma_f32 v83, v204, v82, v39
    v_mul_f32 v36, v206, v68
    v_mul_f32 v37, v206, v84
    v_fma_f32 v36, -v207, v84, v36
    v_fma_f32 v37, v207, v68, v37
    v_fma_f32 v36, -v144, v32, v36
    v_fma_f32 v37, -v144, v33, v37
    v_mul_f32 v36, v160, v36
    v_mul_f32 v37, v160, v37
    v_fma_f32 v36, -v205, v83, v36
    v_fma_f32 v37, v205, v67, v37
    v_fma_f32 v68, v204, v67, v36
    v_fma_f32 v84, v204, v83, v37
    v_mul_f32 v38, v206, v69
    v_mul_f32 v39, v206, v85
    v_fma_f32 v38, -v207, v85, v38
    v_fma_f32 v39, v207, v69, v39
    v_fma_f32 v38, -v145, v32, v38
    v_fma_f32 v39, -v145, v33, v39
    v_mul_f32 v38, v161, v38
    v_mul_f32 v39, v161, v39
    v_fma_f32 v38, -v205, v84, v38
    v_fma_f32 v39, v205, v68, v39
    v_fma_f32 v69, v204, v68, v38
    v_fma_f32 v85, v204, v84, v39
    v_mul_f32 v36, v206, v70
    v_mul_f32 v37, v206, v86
    v_fma_f32 v36, -v207, v86, v36
    v_fma_f32 v37, v207, v70, v37
    v_fma_f32 v36, -v146, v32, v36
    v_fma_f32 v37, -v146, v33, v37
    v_mul_f32 v36, v162, v36
    v_mul_f32 v37, v162, v37
    v_fma_f32 v36, -v205, v85, v36
    v_fma_f32 v37, v205, v69, v37
    v_fma_f32 v70, v204, v69, v36
    v_fma_f32 v86, v204, v85, v37
    v_mul_f32 v38, v206, v71
    v_mul_f32 v39, v206, v87
    v_fma_f32 v38, -v207, v87, v38
    v_fma_f32 v39, v207, v71, v39
    v_fma_f32 v38, -v147, v32, v38
    v_fma_f32 v39, -v147, v33, v39
    v_mul_f32 v38, v163, v38
    v_mul_f32 v39, v163, v39
    v_fma_f32 v38, -v205, v86, v38
    v_fma_f32 v39, v205, v70, v39
    v_fma_f32 v71, v204, v70, v38
    v_fma_f32 v87, v204, v86, v39
    s_waitcnt vmcnt(9)
    v_cmp_ne_u32 s[6:7], v238, v236
    s_nop 1
    s_cmp_eq_u64 s[6:7], 0
    s_cbranch_scc1 kp1_ok
    s_mov_b32 s3, 0
kp1_lp:
    s_sleep 1
    buffer_load_dword v238, v18, s[64:67], 0 offen offset:0 sc1
    s_waitcnt vmcnt(0)
    v_cmp_ne_u32 s[6:7], v238, v236
    s_add_u32 s3, s3, 1
    s_nop 0
    s_cmp_eq_u64 s[6:7], 0
    s_cbranch_scc1 kp1_ok
    s_cmp_lt_u32 s3, 200000
    s_cbranch_scc1 kp1_lp
kp1_ok:
    buffer_load_dwordx4 a[0:3], v17, s[60:63], s17 offen offset:0 sc1
    v_mul_f32 v36, v206, v72
    v_mul_f32 v37, v206, v88
    v_fma_f32 v36, -v207, v88, v36
    v_fma_f32 v37, v207, v72, v37
    v_fma_f32 v36, -v148, v32, v36
    v_fma_f32 v37, -v148, v33, v37
    buffer_load_dwordx4 a[4:7], v17, s[60:63], s17 offen offset:256 sc1
    v_mul_f32 v36, v164, v36
    v_mul_f32 v37, v164, v37
    v_fma_f32 v36, -v205, v87, v36
    v_fma_f32 v37, v205, v71, v37
    v_fma_f32 v72, v204, v71, v36
    v_fma_f32 v88, v204, v87, v37
    buffer_load_dwordx4 a[8:11], v239, s[60:63], s17 offen sc1
    v_mul_f32 v38, v206, v73
    v_mul_f32 v39, v206, v89
    v_fma_f32 v38, -v207, v89, v38
    v_fma_f32 v39, v207, v73, v39
    v_fma_f32 v38, -v149, v32, v38
    v_fma_f32 v39, -v149, v33, v39
    buffer_load_dwordx4 a[12:15], v16, s[56:59], s16 offen offset:0 sc1
    v_mul_f32 v38, v165, v38
    v_mul_f32 v39, v165, v39
    v_fma_f32 v38, -v205, v88, v38
    v_fma_f32 v39, v205, v72, v39
    v_fma_f32 v73, v204, v72, v38
    v_fma_f32 v89, v204, v88, v39
    buffer_load_dwordx4 a[16:19], v16, s[56:59], s16 offen offset:256 sc1
    v_mul_f32 v36, v206, v74
    v_mul_f32 v37, v206, v90
    v_fma_f32 v36, -v207, v90, v36
    v_fma_f32 v37, v207, v74, v37
    v_fma_f32 v36, -v150, v32, v36
    v_fma_f32 v37, -v150, v33, v37
    buffer_load_dwordx4 a[20:23], v16, s[56:59], s16 offen offset:512 sc1
    v_mul_f32 v36, v166, v36
    v_mul_f32 v37, v166, v37
    v_fma_f32 v36, -v205, v89, v36
    v_fma_f32 v37, v205, v73, v37
    v_fma_f32 v74, v204, v73, v36
    v_fma_f32 v90, v204, v89, v37
    buffer_load_dwordx4 a[24:27], v16, s[56:59], s16 offen offset:768 sc1
    s_add_u32 s16, s16, 32768
    s_add_u32 s17, s17, 89088
    v_mul_f32 v38, v206, v75
    v_mul_f32 v39, v206, v91
    v_fma_f32 v38, -v207, v91, v38
    v_fma_f32 v39, v207, v75, v39
    v_fma_f32 v38, -v151, v32, v38
    v_fma_f32 v39, -v151, v33, v39
    buffer_load_dwordx4 a[28:31], v17, s[60:63], s17 offen offset:0 sc1
    v_mul_f32 v38, v167, v38
    v_mul_f32 v39, v167, v39
    v_fma_f32 v38, -v205, v90, v38
    v_fma_f32 v39, v205, v74, v39
    v_fma_f32 v75, v204, v74, v38
    v_fma_f32 v91, v204, v90, v39
    buffer_load_dwordx4 a[32:35], v17, s[60:63], s17 offen offset:256 sc1
    v_mul_f32 v36, v206, v76
    v_mul_f32 v37, v206, v92
    v_fma_f32 v36, -v207, v92, v36
    v_fma_f32 v37, v207, v76, v37
    v_fma_f32 v36, -v152, v32, v36
    v_fma_f32 v37, -v152, v33, v37
    buffer_load_dwordx4 a[36:39], v239, s[60:63], s17 offen sc1
    v_mul_f32 v36, v168, v36
    v_mul_f32 v37, v168, v37
    v_fma_f32 v36, -v205, v91, v36
    v_fma_f32 v37, v205, v75, v37
    v_fma_f32 v76, v204, v75, v36
    v_fma_f32 v92, v204, v91, v37
    buffer_load_dwordx4 a[40:43], v16, s[56:59], s16 offen offset:0 sc1
    v_mul_f32 v38, v206, v77
    v_mul_f32 v39, v206, v93
    v_fma_f32 v38, -v207, v93, v38
    v_fma_f32 v39, v207, v77, v39
    v_fma_f32 v38, -v153, v32, v38
    v_fma_f32 v39, -v153, v33, v39
    buffer_load_dwordx4 a[44:47], v16, s[56:59], s16 offen offset:256 sc1
    v_mul_f32 v38, v169, v38
    v_mul_f32 v39, v169, v39
    v_fma_f32 v38, -v205, v92, v38
    v_fma_f32 v39, v205, v76, v39
    v_fma_f32 v77, v204, v76, v38
    v_fma_f32 v93, v204, v92, v39
    buffer_load_dwordx4 a[48:51], v16, s[56:59], s16 offen offset:512 sc1
    v_mul_f32 v36, v206, v78
    v_mul_f32 v37, v206, v94
    v_fma_f32 v36, -v207, v94, v36
    v_fma_f32 v37, v207, v78, v37
    v_fma_f32 v36, -v154, v32, v36
    v_fma_f32 v37, -v154, v33, v37
    buffer_load_dwordx4 a[52:55], v16, s[56:59], s16 offen offset:768 sc1
    s_add_u32 s16, s16, 32768
    s_add_u32 s17, s17, 89088
    v_mul_f32 v36, v170, v36
    v_mul_f32 v37, v170, v37
    v_fma_f32 v36, -v205, v93, v36
    v_fma_f32 v37, v205, v77, v37
    v_fma_f32 v78, v204, v77, v36
    v_fma_f32 v94, v204, v93, v37
    buffer_load_dwordx4 a[56:59], v17, s[60:63], s17 offen offset:0 sc1
    v_mul_f32 v38, v206, v79
    v_mul_f32 v39, v206, v95
    v_fma_f32 v38, -v207, v95, v38
    v_fma_f32 v39, v207, v79, v39
    v_fma_f32 v38, -v155, v32, v38
    v_fma_f32 v39, -v155, v33, v39
    buffer_load_dwordx4 a[60:63], v17, s[60:63], s17 offen offset:256 sc1
    v_mul_f32 v38, v171, v38
    v_mul_f32 v39, v171, v39
    v_fma_f32 v38, -v205, v94, v38
    v_fma_f32 v39, v205, v78, v39
    v_fma_f32 v79, v204, v78, v38
    v_fma_f32 v95, v204, v94, v39
    buffer_load_dwordx4 a[64:67], v239, s[60:63], s17 offen sc1
    v_mov_b32 v40, v79
    v_mov_b32 v41, v95
    v_lshlrev_b32 v30, 3, v1
    v_add_u32 v30, s12, v30
    v_lshlrev_b32 v31, 3, v2
    v_add_u32 v31, s12, v31
    buffer_load_dwordx4 a[68:71], v16, s[56:59], s16 offen offset:0 sc1
    ds_write_b64 v30, v[40:41] offset:1024
    ds_read_b64 v[44:45], v31 offset:1024
    ds_read_b64 v[46:47], v31 offset:1152
    ds_read_b64 v[48:49], v31 offset:1280
    ds_read_b64 v[50:51], v31 offset:1408
    s_sub_u32 s77, 31, s73
    s_lshl_b32 s77, s77, 8
    v_lshlrev_b32 v60, 4, v2
    v_mov_b32 v58, v236
    buffer_load_dwordx4 a[72:75], v16, s[56:59], s16 offen offset:256 sc1
    s_add_u32 s44, s36, 8388608
    s_addc_u32 s45, s37, 0
    s_and_b32 s45, s45, 0xffff
    s_mov_b32 s46, 4194304
    s_mov_b32 s47, 0x20000
    s_add_u32 s48, s36, 12582912
    s_addc_u32 s49, s37, 0
    s_and_b32 s49, s49, 0xffff
    s_mov_b32 s50, 1409024
    s_mov_b32 s51, 0x20000
    buffer_load_dwordx4 a[76:79], v16, s[56:59], s16 offen offset:512 sc1
    s_mov_b32 s52, s28
    s_and_b32 s53, s29, 0xffff
    s_mov_b32 s54, 5636096
    s_mov_b32 s55, 0x20000
    s_waitcnt lgkmcnt(0)
    v_fma_f32 v52, v208, v44, v46
    buffer_load_dwordx4 a[80:83], v16, s[56:59], s16 offen offset:768 sc1
    s_add_u32 s16, s16, 32768
    s_add_u32 s17, s17, 89088
    v_fma_f32 v53, v208, v45, v47
    v_fma_f32 v52, -v209, v45, v52
    v_fma_f32 v53, v209, v44, v53
    v_fma_f32 v54, v208, v52, v48
    v_fma_f32 v55, v208, v53, v49
    v_fma_f32 v54, -v209, v53, v54
    buffer_load_dwordx4 a[84:87], v17, s[60:63], s17 offen offset:0 sc1
    v_fma_f32 v55, v209, v52, v55
    v_fma_f32 v56, v208, v54, v50
    v_fma_f32 v57, v208, v55, v51
    v_fma_f32 v56, -v209, v55, v56
    v_fma_f32 v57, v209, v54, v57
    s_mov_b64 exec, 0xffff
    buffer_store_dwordx4 v[56:59], v60, s[40:43], s77 offen sc1
    s_mov_b64 exec, -1
    buffer_load_dwordx4 a[88:91], v17, s[60:63], s17 offen offset:256 sc1
    s_mov_b32 s8, s26
    s_and_b32 s9, s27, 0xffff
    s_mov_b32 s10, 2752
    s_mov_b32 s11, 0x20000
    s_mul_i32 s77, s75, 96
    s_lshl_b32 s78, s72, 5
    s_add_u32 s18, s77, s78
    s_buffer_load_dwordx8 s[80:87], s[8:11], s18
    buffer_load_dwordx4 a[92:95], v239, s[60:63], s17 offen sc1
    s_sub_u32 s77, 32, s73
    s_lshl_b32 s77, s77, 8
    v_lshl_add_u32 v60, v3, 11, v60
    v_add_u32 v60, s77, v60
    v_lshlrev_b32 v176, 16, v214
    v_and_b32 v177, 0xffff0000, v214
    buffer_load_dwordx4 a[96:99], v16, s[56:59], s16 offen offset:0 sc1
    v_lshlrev_b32 v178, 16, v215
    v_and_b32 v179, 0xffff0000, v215
    v_lshlrev_b32 v180, 16, v216
    v_and_b32 v181, 0xffff0000, v216
    v_lshlrev_b32 v182, 16, v217
    v_and_b32 v183, 0xffff0000, v217
    buffer_load_dwordx4 a[100:103], v16, s[56:59], s16 offen offset:256 sc1
    v_sub_f32 v180, v180, v240
    v_sub_f32 v181, v181, v240
    v_sub_f32 v182, v182, v240
    v_sub_f32 v183, v183, v240
    v_cvt_pk_bf16_f32 v184, v180, v181
    v_cvt_pk_bf16_f32 v185, v182, v183
    buffer_load_dwordx4 a[104:107], v16, s[56:59], s16 offen offset:512 sc1
    v_lshlrev_b32 v180, 16, v184
    v_and_b32 v181, 0xffff0000, v184
    v_lshlrev_b32 v182, 16, v185
    v_and_b32 v183, 0xffff0000, v185
    v_mul_f32 v180, v180, v244
    v_mul_f32 v181, v181, v244
    buffer_load_dwordx4 a[108:111], v16, s[56:59], s16 offen offset:768 sc1
    s_add_u32 s16, s16, 32768
    s_add_u32 s17, s17, 89088
    v_mul_f32 v182, v182, v244
    v_mul_f32 v183, v183, v244
    v_cvt_pk_bf16_f32 v184, v180, v181
    v_cvt_pk_bf16_f32 v185, v182, v183
    v_lshlrev_b32 v180, 16, v184
    v_and_b32 v181, 0xffff0000, v184
    s_waitcnt vmcnt(22)
    v_mfma_f32_16x16x32_bf16 v[96:99], a[0:3], a[12:15], 0
    buffer_load_dwordx4 a[112:115], v17, s[60:63], s17 offen offset:0 sc1
    v_lshlrev_b32 v182, 16, v185
    v_and_b32 v183, 0xffff0000, v185
    v_mul_f32 v180, v180, v176
    v_mul_f32 v181, v181, v177
    v_mul_f32 v182, v182, v178
    v_mfma_f32_16x16x32_bf16 v[100:103], a[0:3], a[16:19], 0
    buffer_load_dwordx4 a[116:119], v17, s[60:63], s17 offen offset:256 sc1
    v_mul_f32 v183, v183, v179
    v_cvt_pk_bf16_f32 v224, v180, v181
    v_cvt_pk_bf16_f32 v225, v182, v183
    v_lshlrev_b32 v180, 16, v218
    v_and_b32 v181, 0xffff0000, v218
    v_mfma_f32_16x16x32_bf16 v[104:107], a[0:3], a[20:23], 0
    v_lshlrev_b32 v182, 16, v219
    v_and_b32 v183, 0xffff0000, v219
    v_sub_f32 v180, v180, v241
    v_sub_f32 v181, v181, v241
    v_sub_f32 v182, v182, v241
    v_mfma_f32_16x16x32_bf16 v[108:111], a[0:3], a[24:27], 0
    buffer_load_dwordx4 a[120:123], v239, s[60:63], s17 offen sc1
    v_sub_f32 v183, v183, v241
    v_cvt_pk_bf16_f32 v184, v180, v181
    v_cvt_pk_bf16_f32 v185, v182, v183
    v_lshlrev_b32 v180, 16, v184
    v_and_b32 v181, 0xffff0000, v184
    v_mfma_f32_16x16x32_bf16 v[112:115], a[4:7], a[12:15], 0
    v_lshlrev_b32 v182, 16, v185
    v_and_b32 v183, 0xffff0000, v185
    v_mul_f32 v180, v180, v245
    v_mul_f32 v181, v181, v245
    v_mul_f32 v182, v182, v245
    v_mfma_f32_16x16x32_bf16 v[116:119], a[4:7], a[16:19], 0
    buffer_load_dwordx4 a[124:127], v16, s[56:59], s16 offen offset:0 sc1
    v_mul_f32 v183, v183, v245
    v_cvt_pk_bf16_f32 v184, v180, v181
    v_cvt_pk_bf16_f32 v185, v182, v183
    v_lshlrev_b32 v180, 16, v184
    v_and_b32 v181, 0xffff0000, v184
    v_mfma_f32_16x16x32_bf16 v[120:123], a[4:7], a[20:23], 0
    buffer_load_dwordx4 a[128:131], v16, s[56:59], s16 offen offset:256 sc1
    v_lshlrev_b32 v182, 16, v185
    v_and_b32 v183, 0xffff0000, v185
    v_mul_f32 v180, v180, v176
    v_mul_f32 v181, v181, v177
    v_mul_f32 v182, v182, v178
    v_mfma_f32_16x16x32_bf16 v[124:127], a[4:7], a[24:27], 0
    v_mul_f32 v183, v183, v179
    v_cvt_pk_bf16_f32 v226, v180, v181
    v_cvt_pk_bf16_f32 v227, v182, v183
    v_lshlrev_b32 v180, 16, v220
    v_and_b32 v181, 0xffff0000, v220
    v_mfma_f32_16x16x32_bf16 v[128:131], a[8:11], a[12:15], 0
    buffer_load_dwordx4 a[132:135], v16, s[56:59], s16 offen offset:512 sc1
    v_lshlrev_b32 v182, 16, v221
    v_and_b32 v183, 0xffff0000, v221
    v_sub_f32 v180, v180, v242
    v_sub_f32 v181, v181, v242
    v_sub_f32 v182, v182, v242
    v_mfma_f32_16x16x32_bf16 v[132:135], a[8:11], a[16:19], 0
    v_sub_f32 v183, v183, v242
    v_cvt_pk_bf16_f32 v184, v180, v181
    v_cvt_pk_bf16_f32 v185, v182, v183
    v_lshlrev_b32 v180, 16, v184
    v_and_b32 v181, 0xffff0000, v184
    v_mfma_f32_16x16x32_bf16 v[136:139], a[8:11], a[20:23], 0
    buffer_load_dwordx4 a[136:139], v16, s[56:59], s16 offen offset:768 sc1
    s_add_u32 s16, s16, 32768
    s_add_u32 s17, s17, 89088
    v_lshlrev_b32 v182, 16, v185
    v_and_b32 v183, 0xffff0000, v185
    v_mul_f32 v180, v180, v246
    v_mul_f32 v181, v181, v246
    v_mul_f32 v182, v182, v246
    v_mfma_f32_16x16x32_bf16 v[140:143], a[8:11], a[24:27], 0
    v_mul_f32 v183, v183, v246
    v_cvt_pk_bf16_f32 v184, v180, v181
    v_cvt_pk_bf16_f32 v185, v182, v183
    v_lshlrev_b32 v180, 16, v184
    v_and_b32 v181, 0xffff0000, v184
    s_waitcnt vmcnt(22)
    v_mfma_f32_16x16x32_bf16 v[96:99], a[28:31], a[40:43], v[96:99]
    buffer_load_dwordx4 a[0:3], v17, s[60:63], s17 offen offset:0 sc1
    v_lshlrev_b32 v182, 16, v185
    v_and_b32 v183, 0xffff0000, v185
    v_mul_f32 v180, v180, v176
    v_mul_f32 v181, v181, v177
    v_mul_f32 v182, v182, v178
    v_mfma_f32_16x16x32_bf16 v[100:103], a[28:31], a[44:47], v[100:103]
    buffer_load_dwordx4 a[4:7], v17, s[60:63], s17 offen offset:256 sc1
    v_mul_f32 v183, v183, v179
    v_cvt_pk_bf16_f32 v228, v180, v181
    v_cvt_pk_bf16_f32 v229, v182, v183
    v_lshlrev_b32 v180, 16, v222
    v_and_b32 v181, 0xffff0000, v222
    v_mfma_f32_16x16x32_bf16 v[104:107], a[28:31], a[48:51], v[104:107]
    v_lshlrev_b32 v182, 16, v223
    v_and_b32 v183, 0xffff0000, v223
    v_sub_f32 v180, v180, v243
    v_sub_f32 v181, v181, v243
    v_sub_f32 v182, v182, v243
    v_mfma_f32_16x16x32_bf16 v[108:111], a[28:31], a[52:55], v[108:111]
    buffer_load_dwordx4 a[8:11], v239, s[60:63], s17 offen sc1
    v_sub_f32 v183, v183, v243
    v_cvt_pk_bf16_f32 v184, v180, v181
    v_cvt_pk_bf16_f32 v185, v182, v183
    v_lshlrev_b32 v180, 16, v184
    v_and_b32 v181, 0xffff0000, v184
    v_mfma_f32_16x16x32_bf16 v[112:115], a[32:35], a[40:43], v[112:115]
    v_lshlrev_b32 v182, 16, v185
    v_and_b32 v183, 0xffff0000, v185
    v_mul_f32 v180, v180, v247
    v_mul_f32 v181, v181, v247
    v_mul_f32 v182, v182, v247
    v_mfma_f32_16x16x32_bf16 v[116:119], a[32:35], a[44:47], v[116:119]
    buffer_load_dwordx4 a[12:15], v16, s[56:59], s16 offen offset:0 sc1
    v_mul_f32 v183, v183, v247
    v_cvt_pk_bf16_f32 v184, v180, v181
    v_cvt_pk_bf16_f32 v185, v182, v183
    v_lshlrev_b32 v180, 16, v184
    v_and_b32 v181, 0xffff0000, v184
    v_mfma_f32_16x16x32_bf16 v[120:123], a[32:35], a[48:51], v[120:123]
    buffer_load_dwordx4 a[16:19], v16, s[56:59], s16 offen offset:256 sc1
    v_lshlrev_b32 v182, 16, v185
    v_and_b32 v183, 0xffff0000, v185
    v_mul_f32 v180, v180, v176
    v_mul_f32 v181, v181, v177
    v_mul_f32 v182, v182, v178
    v_mfma_f32_16x16x32_bf16 v[124:127], a[32:35], a[52:55], v[124:127]
    v_mul_f32 v183, v183, v179
    v_cvt_pk_bf16_f32 v230, v180, v181
    v_cvt_pk_bf16_f32 v231, v182, v183
    v_lshlrev_b32 v232, 16, v232
    v_lshlrev_b32 v233, 16, v233
    v_mfma_f32_16x16x32_bf16 v[128:131], a[36:39], a[40:43], v[128:131]
    buffer_load_dwordx4 a[20:23], v16, s[56:59], s16 offen offset:512 sc1
    v_lshlrev_b32 v234, 16, v234
    v_lshlrev_b32 v235, 16, v235
    v_mfma_f32_16x16x32_bf16 v[132:135], a[36:39], a[44:47], v[132:135]
    v_mfma_f32_16x16x32_bf16 v[136:139], a[36:39], a[48:51], v[136:139]
    buffer_load_dwordx4 a[24:27], v16, s[56:59], s16 offen offset:768 sc1
    s_add_u32 s16, s16, 32768
    s_add_u32 s17, s17, 89088
    v_mfma_f32_16x16x32_bf16 v[140:143], a[36:39], a[52:55], v[140:143]
    s_waitcnt vmcnt(22)
    v_mfma_f32_16x16x32_bf16 v[96:99], a[56:59], a[68:71], v[96:99]
    buffer_load_dwordx4 a[28:31], v17, s[60:63], s17 offen offset:0 sc1
    v_mfma_f32_16x16x32_bf16 v[100:103], a[56:59], a[72:75], v[100:103]
    buffer_load_dwordx4 a[32:35], v17, s[60:63], s17 offen offset:256 sc1
    v_mfma_f32_16x16x32_bf16 v[104:107], a[56:59], a[76:79], v[104:107]
    v_mfma_f32_16x16x32_bf16 v[108:111], a[56:59], a[80:83], v[108:111]
    buffer_load_dwordx4 a[36:39], v239, s[60:63], s17 offen sc1
    v_mfma_f32_16x16x32_bf16 v[112:115], a[60:63], a[68:71], v[112:115]
    v_mfma_f32_16x16x32_bf16 v[116:119], a[60:63], a[72:75], v[116:119]
    buffer_load_dwordx4 a[40:43], v16, s[56:59], s16 offen offset:0 sc1
    v_mfma_f32_16x16x32_bf16 v[120:123], a[60:63], a[76:79], v[120:123]
    buffer_load_dwordx4 a[44:47], v16, s[56:59], s16 offen offset:256 sc1
    v_mfma_f32_16x16x32_bf16 v[124:127], a[60:63], a[80:83], v[124:127]
    v_mfma_f32_16x16x32_bf16 v[128:131], a[64:67], a[68:71], v[128:131]
    buffer_load_dwordx4 a[48:51], v16, s[56:59], s16 offen offset:512 sc1
    v_mfma_f32_16x16x32_bf16 v[132:135], a[64:67], a[72:75], v[132:135]
    v_mfma_f32_16x16x32_bf16 v[136:139], a[64:67], a[76:79], v[136:139]
    buffer_load_dwordx4 a[52:55], v16, s[56:59], s16 offen offset:768 sc1
    s_add_u32 s16, s16, 32768
    s_add_u32 s17, s17, 89088
    v_mfma_f32_16x16x32_bf16 v[140:143], a[64:67], a[80:83], v[140:143]
    s_waitcnt vmcnt(21)
    v_mfma_f32_16x16x32_bf16 v[96:99], a[84:87], a[96:99], v[96:99]
    buffer_load_dwordx4 v[144:147], v60, s[40:43], 0 offen offset:0 sc1
    buffer_load_dwordx4 v[148:151], v60, s[40:43], 0 offen offset:256 sc1
    v_mfma_f32_16x16x32_bf16 v[100:103], a[84:87], a[100:103], v[100:103]
    buffer_load_dwordx4 v[152:155], v60, s[40:43], 0 offen offset:512 sc1
    v_mfma_f32_16x16x32_bf16 v[104:107], a[84:87], a[104:107], v[104:107]
    buffer_load_dwordx4 v[156:159], v60, s[40:43], 0 offen offset:768 sc1
    v_mfma_f32_16x16x32_bf16 v[108:111], a[84:87], a[108:111], v[108:111]
    buffer_load_dwordx4 v[160:163], v60, s[40:43], 0 offen offset:1024 sc1
    v_mfma_f32_16x16x32_bf16 v[112:115], a[88:91], a[96:99], v[112:115]
    buffer_load_dwordx4 v[164:167], v60, s[40:43], 0 offen offset:1280 sc1
    buffer_load_dwordx4 v[168:171], v60, s[40:43], 0 offen offset:1536 sc1
    v_mfma_f32_16x16x32_bf16 v[116:119], a[88:91], a[100:103], v[116:119]
    buffer_load_dwordx4 v[172:175], v60, s[40:43], 0 offen offset:1792 sc1
    v_mfma_f32_16x16x32_bf16 v[120:123], a[88:91], a[104:107], v[120:123]
    buffer_load_dwordx4 a[56:59], v17, s[60:63], s17 offen offset:0 sc1
    v_mfma_f32_16x16x32_bf16 v[124:127], a[88:91], a[108:111], v[124:127]
    buffer_load_dwordx4 a[60:63], v17, s[60:63], s17 offen offset:256 sc1
    v_mfma_f32_16x16x32_bf16 v[128:131], a[92:95], a[96:99], v[128:131]
    buffer_load_dwordx4 a[64:67], v239, s[60:63], s17 offen sc1
    buffer_load_dwordx4 a[68:71], v16, s[56:59], s16 offen offset:0 sc1
    v_mfma_f32_16x16x32_bf16 v[132:135], a[92:95], a[100:103], v[132:135]
    buffer_load_dwordx4 a[72:75], v16, s[56:59], s16 offen offset:256 sc1
    v_mfma_f32_16x16x32_bf16 v[136:139], a[92:95], a[104:107], v[136:139]
    buffer_load_dwordx4 a[76:79], v16, s[56:59], s16 offen offset:512 sc1
    v_mfma_f32_16x16x32_bf16 v[140:143], a[92:95], a[108:111], v[140:143]
    buffer_load_dwordx4 a[80:83], v16, s[56:59], s16 offen offset:768 sc1
    s_add_u32 s16, s16, 32768
    s_add_u32 s17, s17, 89088
    s_waitcnt vmcnt(29)
    v_mfma_f32_16x16x32_bf16 v[96:99], a[112:115], a[124:127], v[96:99]
    buffer_load_dwordx4 a[84:87], v17, s[60:63], s17 offen offset:0 sc1
    v_mfma_f32_16x16x32_bf16 v[100:103], a[112:115], a[128:131], v[100:103]
    buffer_load_dwordx4 a[88:91], v17, s[60:63], s17 offen offset:256 sc1
    v_mfma_f32_16x16x32_bf16 v[104:107], a[112:115], a[132:135], v[104:107]
    v_mfma_f32_16x16x32_bf16 v[108:111], a[112:115], a[136:139], v[108:111]
    buffer_load_dwordx4 a[92:95], v239, s[60:63], s17 offen sc1
    v_mfma_f32_16x16x32_bf16 v[112:115], a[116:119], a[124:127], v[112:115]
    v_mfma_f32_16x16x32_bf16 v[116:119], a[116:119], a[128:131], v[116:119]
    buffer_load_dwordx4 a[96:99], v16, s[56:59], s16 offen offset:0 sc1
    v_mfma_f32_16x16x32_bf16 v[120:123], a[116:119], a[132:135], v[120:123]
    buffer_load_dwordx4 a[100:103], v16, s[56:59], s16 offen offset:256 sc1
    v_mfma_f32_16x16x32_bf16 v[124:127], a[116:119], a[136:139], v[124:127]
    v_mfma_f32_16x16x32_bf16 v[128:131], a[120:123], a[124:127], v[128:131]
    buffer_load_dwordx4 a[104:107], v16, s[56:59], s16 offen offset:512 sc1
    v_mfma_f32_16x16x32_bf16 v[132:135], a[120:123], a[128:131], v[132:135]
    v_mfma_f32_16x16x32_bf16 v[136:139], a[120:123], a[132:135], v[136:139]
    buffer_load_dwordx4 a[108:111], v16, s[56:59], s16 offen offset:768 sc1
    s_add_u32 s16, s16, 32768
    s_add_u32 s17, s17, 89088
    v_mfma_f32_16x16x32_bf16 v[140:143], a[120:123], a[136:139], v[140:143]
    s_waitcnt vmcnt(29)
    v_mfma_f32_16x16x32_bf16 v[96:99], a[0:3], a[12:15], v[96:99]
    buffer_load_dwordx4 a[112:115], v17, s[60:63], s17 offen offset:0 sc1
    v_mfma_f32_16x16x32_bf16 v[100:103], a[0:3], a[16:19], v[100:103]
    buffer_load_dwordx4 a[116:119], v17, s[60:63], s17 offen offset:256 sc1
    v_mfma_f32_16x16x32_bf16 v[104:107], a[0:3], a[20:23], v[104:107]
    v_mfma_f32_16x16x32_bf16 v[108:111], a[0:3], a[24:27], v[108:111]
    buffer_load_dwordx4 a[120:123], v239, s[60:63], s17 offen sc1
    v_mfma_f32_16x16x32_bf16 v[112:115], a[4:7], a[12:15], v[112:115]
    v_mfma_f32_16x16x32_bf16 v[116:119], a[4:7], a[16:19], v[116:119]
    buffer_load_dwordx4 a[124:127], v16, s[56:59], s16 offen offset:0 sc1
    v_mfma_f32_16x16x32_bf16 v[120:123], a[4:7], a[20:23], v[120:123]
    buffer_load_dwordx4 a[128:131], v16, s[56:59], s16 offen offset:256 sc1
    v_mfma_f32_16x16x32_bf16 v[124:127], a[4:7], a[24:27], v[124:127]
    v_mfma_f32_16x16x32_bf16 v[128:131], a[8:11], a[12:15], v[128:131]
    buffer_load_dwordx4 a[132:135], v16, s[56:59], s16 offen offset:512 sc1
    v_mfma_f32_16x16x32_bf16 v[132:135], a[8:11], a[16:19], v[132:135]
    v_mfma_f32_16x16x32_bf16 v[136:139], a[8:11], a[20:23], v[136:139]
    buffer_load_dwordx4 a[136:139], v16, s[56:59], s16 offen offset:768 sc1
    s_add_u32 s16, s16, 32768
    s_add_u32 s17, s17, 89088
    v_mfma_f32_16x16x32_bf16 v[140:143], a[8:11], a[24:27], v[140:143]
    s_waitcnt vmcnt(29)
    v_mfma_f32_16x16x32_bf16 v[96:99], a[28:31], a[40:43], v[96:99]
    buffer_load_dwordx4 a[0:3], v17, s[60:63], s17 offen offset:0 sc1
    s_waitcnt vmcnt(22)
    s_mov_b32 s77, 0
    v_cmp_eq_u32 s[6:7], v146, v236
    s_nop 1
    s_bcnt1_i32_b64 s78, s[6:7]
    s_add_u32 s77, s77, s78
    v_cmp_eq_u32 s[6:7], v150, v236
    s_nop 1
    s_bcnt1_i32_b64 s78, s[6:7]
    s_add_u32 s77, s77, s78
    v_cmp_eq_u32 s[6:7], v154, v236
    s_nop 1
    s_bcnt1_i32_b64 s78, s[6:7]
    s_add_u32 s77, s77, s78
    v_cmp_eq_u32 s[6:7], v158, v236
    s_nop 1
    s_bcnt1_i32_b64 s78, s[6:7]
    s_add_u32 s77, s77, s78
    v_cmp_eq_u32 s[6:7], v162, v236
    s_nop 1
    s_bcnt1_i32_b64 s78, s[6:7]
    s_add_u32 s77, s77, s78
    v_cmp_eq_u32 s[6:7], v166, v236
    s_nop 1
    s_bcnt1_i32_b64 s78, s[6:7]
    s_add_u32 s77, s77, s78
    v_cmp_eq_u32 s[6:7], v170, v236
    s_nop 1
    s_bcnt1_i32_b64 s78, s[6:7]
    s_add_u32 s77, s77, s78
    v_cmp_eq_u32 s[6:7], v174, v236
    s_nop 1
    s_bcnt1_i32_b64 s78, s[6:7]
    s_add_u32 s77, s77, s78
    s_lshl_b32 s78, s73, 4
    s_cmp_eq_u32 s77, s78
    s_cbranch_scc1 klb_ok
    s_mov_b32 s3, 0
klb_lp:
    s_sleep 4
    buffer_load_dwordx4 v[144:147], v60, s[40:43], 0 offen offset:0 sc1
    buffer_load_dwordx4 v[148:151], v60, s[40:43], 0 offen offset:256 sc1
    buffer_load_dwordx4 v[152:155], v60, s[40:43], 0 offen offset:512 sc1
    buffer_load_dwordx4 v[156:159], v60, s[40:43], 0 offen offset:768 sc1
    buffer_load_dwordx4 v[160:163], v60, s[40:43], 0 offen offset:1024 sc1
    buffer_load_dwordx4 v[164:167], v60, s[40:43], 0 offen offset:1280 sc1
    buffer_load_dwordx4 v[168:171], v60, s[40:43], 0 offen offset:1536 sc1
    buffer_load_dwordx4 v[172:175], v60, s[40:43], 0 offen offset:1792 sc1
    s_waitcnt vmcnt(0)
    s_add_u32 s3, s3, 1
    s_mov_b32 s77, 0
    v_cmp_eq_u32 s[6:7], v146, v236
    s_nop 1
    s_bcnt1_i32_b64 s78, s[6:7]
    s_add_u32 s77, s77, s78
    v_cmp_eq_u32 s[6:7], v150, v236
    s_nop 1
    s_bcnt1_i32_b64 s78, s[6:7]
    s_add_u32 s77, s77, s78
    v_cmp_eq_u32 s[6:7], v154, v236
    s_nop 1
    s_bcnt1_i32_b64 s78, s[6:7]
    s_add_u32 s77, s77, s78
    v_cmp_eq_u32 s[6:7], v158, v236
    s_nop 1
    s_bcnt1_i32_b64 s78, s[6:7]
    s_add_u32 s77, s77, s78
    v_cmp_eq_u32 s[6:7], v162, v236
    s_nop 1
    s_bcnt1_i32_b64 s78, s[6:7]
    s_add_u32 s77, s77, s78
    v_cmp_eq_u32 s[6:7], v166, v236
    s_nop 1
    s_bcnt1_i32_b64 s78, s[6:7]
    s_add_u32 s77, s77, s78
    v_cmp_eq_u32 s[6:7], v170, v236
    s_nop 1
    s_bcnt1_i32_b64 s78, s[6:7]
    s_add_u32 s77, s77, s78
    v_cmp_eq_u32 s[6:7], v174, v236
    s_nop 1
    s_bcnt1_i32_b64 s78, s[6:7]
    s_add_u32 s77, s77, s78
    s_lshl_b32 s78, s73, 4
    s_cmp_eq_u32 s77, s78
    s_cbranch_scc1 klb_ok
    s_cmp_lt_u32 s3, 200000
    s_cbranch_scc1 klb_lp
klb_ok:
    v_mfma_f32_16x16x32_bf16 v[100:103], a[28:31], a[44:47], v[100:103]
    buffer_load_dwordx4 a[4:7], v17, s[60:63], s17 offen offset:256 sc1
    v_cmp_lt_u32 s[6:7], 0, v3
    v_cmp_lt_u32 s[8:9], 1, v3
    v_cmp_lt_u32 s[10:11], 2, v3
    v_fma_f32 v176, v210, v172, v168
    v_fma_f32 v177, v210, v173, v169
    v_fma_f32 v176, -v211, v173, v176
    v_fma_f32 v177, v211, v172, v177
    v_mfma_f32_16x16x32_bf16 v[104:107], a[28:31], a[48:51], v[104:107]
    v_fma_f32 v178, v210, v176, v164
    v_fma_f32 v179, v210, v177, v165
    v_fma_f32 v178, -v211, v177, v178
    v_fma_f32 v179, v211, v176, v179
    v_fma_f32 v176, v210, v178, v160
    v_fma_f32 v177, v210, v179, v161
    v_fma_f32 v176, -v211, v179, v176
    v_mfma_f32_16x16x32_bf16 v[108:111], a[28:31], a[52:55], v[108:111]
    buffer_load_dwordx4 a[8:11], v239, s[60:63], s17 offen sc1
    v_fma_f32 v177, v211, v178, v177
    v_fma_f32 v178, v210, v176, v156
    v_fma_f32 v179, v210, v177, v157
    v_fma_f32 v178, -v211, v177, v178
    v_fma_f32 v179, v211, v176, v179
    v_fma_f32 v176, v210, v178, v152
    v_fma_f32 v177, v210, v179, v153
    v_mfma_f32_16x16x32_bf16 v[112:115], a[32:35], a[40:43], v[112:115]
    v_fma_f32 v176, -v211, v179, v176
    v_fma_f32 v177, v211, v178, v177
    v_fma_f32 v178, v210, v176, v148
    v_fma_f32 v179, v210, v177, v149
    v_fma_f32 v178, -v211, v177, v178
    v_fma_f32 v179, v211, v176, v179
    v_fma_f32 v176, v210, v178, v144
    v_mfma_f32_16x16x32_bf16 v[116:119], a[32:35], a[44:47], v[116:119]
    buffer_load_dwordx4 a[12:15], v16, s[56:59], s16 offen offset:0 sc1
    v_fma_f32 v177, v210, v179, v145
    v_fma_f32 v176, -v211, v179, v176
    v_fma_f32 v177, v211, v178, v177
    ds_write_b64 v30, v[176:177] offset:1024
    ds_read_b64 v[144:145], v31 offset:1024
    ds_read_b64 v[146:147], v31 offset:1152
    ds_read_b64 v[148:149], v31 offset:1280
    v_mfma_f32_16x16x32_bf16 v[120:123], a[32:35], a[48:51], v[120:123]
    buffer_load_dwordx4 a[16:19], v16, s[56:59], s16 offen offset:256 sc1
    ds_read_b64 v[150:151], v31 offset:1408
    s_waitcnt lgkmcnt(0)
    v_fma_f32 v176, v212, v150, v148
    v_fma_f32 v177, v212, v151, v149
    v_fma_f32 v176, -v213, v151, v176
    v_fma_f32 v177, v213, v150, v177
    v_fma_f32 v178, v212, v176, v146
    v_mfma_f32_16x16x32_bf16 v[124:127], a[32:35], a[52:55], v[124:127]
    v_fma_f32 v179, v212, v177, v147
    v_fma_f32 v178, -v213, v177, v178
    v_fma_f32 v179, v213, v176, v179
    v_fma_f32 v176, v212, v178, v144
    v_fma_f32 v177, v212, v179, v145
    v_fma_f32 v176, -v213, v179, v176
    v_fma_f32 v177, v213, v178, v177
    v_mfma_f32_16x16x32_bf16 v[128:131], a[36:39], a[40:43], v[128:131]
    buffer_load_dwordx4 a[20:23], v16, s[56:59], s16 offen offset:512 sc1
    v_fma_f32 v178, v208, v176, v44
    v_fma_f32 v179, v208, v177, v45
    v_fma_f32 v178, -v209, v177, v178
    v_fma_f32 v179, v209, v176, v179
    v_cndmask_b32 v176, v176, v178, s[6:7]
    v_cndmask_b32 v177, v177, v179, s[6:7]
    v_fma_f32 v178, v208, v176, v46
    v_mfma_f32_16x16x32_bf16 v[132:135], a[36:39], a[44:47], v[132:135]
    v_fma_f32 v179, v208, v177, v47
    v_fma_f32 v178, -v209, v177, v178
    v_fma_f32 v179, v209, v176, v179
    v_cndmask_b32 v176, v176, v178, s[8:9]
    v_cndmask_b32 v177, v177, v179, s[8:9]
    v_fma_f32 v178, v208, v176, v48
    v_fma_f32 v179, v208, v177, v49
    v_mfma_f32_16x16x32_bf16 v[136:139], a[36:39], a[48:51], v[136:139]
    buffer_load_dwordx4 a[24:27], v16, s[56:59], s16 offen offset:768 sc1
    s_add_u32 s16, s16, 32768
    s_add_u32 s17, s17, 89088
    v_fma_f32 v178, -v209, v177, v178
    v_fma_f32 v179, v209, v176, v179
    v_cndmask_b32 v176, v176, v178, s[10:11]
    v_cndmask_b32 v177, v177, v179, s[10:11]
    v_mul_f32 v178, v204, v176
    v_mul_f32 v179, v204, v177
    v_fma_f32 v178, -v205, v177, v178
    v_mfma_f32_16x16x32_bf16 v[140:143], a[36:39], a[52:55], v[140:143]
    v_fma_f32 v179, v205, v176, v179
    v_add_f32 v64, v64, v178
    v_add_f32 v80, v80, v179
    v_mul_f32 v176, v204, v178
    v_mul_f32 v177, v204, v179
    v_fma_f32 v176, -v205, v179, v176
    v_fma_f32 v177, v205, v178, v177
    s_waitcnt vmcnt(21)
    v_mfma_f32_16x16x32_bf16 v[96:99], a[56:59], a[68:71], v[96:99]
    buffer_load_dwordx4 a[28:31], v17, s[60:63], s17 offen offset:0 sc1
    v_add_f32 v65, v65, v176
    v_add_f32 v81, v81, v177
    v_mul_f32 v178, v204, v176
    v_mul_f32 v179, v204, v177
    v_fma_f32 v178, -v205, v177, v178
    v_fma_f32 v179, v205, v176, v179
    v_add_f32 v66, v66, v178
    v_mfma_f32_16x16x32_bf16 v[100:103], a[56:59], a[72:75], v[100:103]
    buffer_load_dwordx4 a[32:35], v17, s[60:63], s17 offen offset:256 sc1
    v_add_f32 v82, v82, v179
    v_mul_f32 v176, v204, v178
    v_mul_f32 v177, v204, v179
    v_fma_f32 v176, -v205, v179, v176
    v_fma_f32 v177, v205, v178, v177
    v_add_f32 v67, v67, v176
    v_add_f32 v83, v83, v177
    v_mfma_f32_16x16x32_bf16 v[104:107], a[56:59], a[76:79], v[104:107]
    v_mul_f32 v178, v204, v176
    v_mul_f32 v179, v204, v177
    v_fma_f32 v178, -v205, v177, v178
    v_fma_f32 v179, v205, v176, v179
    v_add_f32 v68, v68, v178
    v_add_f32 v84, v84, v179
    v_mul_f32 v176, v204, v178
    v_mfma_f32_16x16x32_bf16 v[108:111], a[56:59], a[80:83], v[108:111]
    buffer_load_dwordx4 a[36:39], v239, s[60:63], s17 offen sc1
    v_mul_f32 v177, v204, v179
    v_fma_f32 v176, -v205, v179, v176
    v_fma_f32 v177, v205, v178, v177
    v_add_f32 v69, v69, v176
    v_add_f32 v85, v85, v177
    v_mul_f32 v178, v204, v176
    v_mul_f32 v179, v204, v177
    v_mfma_f32_16x16x32_bf16 v[112:115], a[60:63], a[68:71], v[112:115]
    v_fma_f32 v178, -v205, v177, v178
    v_fma_f32 v179, v205, v176, v179
    v_add_f32 v70, v70, v178
    v_add_f32 v86, v86, v179
    v_mul_f32 v176, v204, v178
    v_mul_f32 v177, v204, v179
    v_fma_f32 v176, -v205, v179, v176
    v_mfma_f32_16x16x32_bf16 v[116:119], a[60:63], a[72:75], v[116:119]
    buffer_load_dwordx4 a[40:43], v16, s[56:59], s16 offen offset:0 sc1
    v_fma_f32 v177, v205, v178, v177
    v_add_f32 v71, v71, v176
    v_add_f32 v87, v87, v177
    v_mul_f32 v178, v204, v176
    v_mul_f32 v179, v204, v177
    v_fma_f32 v178, -v205, v177, v178
    v_fma_f32 v179, v205, v176, v179
    v_mfma_f32_16x16x32_bf16 v[120:123], a[60:63], a[76:79], v[120:123]
    buffer_load_dwordx4 a[44:47], v16, s[56:59], s16 offen offset:256 sc1
    v_add_f32 v72, v72, v178
    v_add_f32 v88, v88, v179
    v_mul_f32 v176, v204, v178
    v_mul_f32 v177, v204, v179
    v_fma_f32 v176, -v205, v179, v176
    v_fma_f32 v177, v205, v178, v177
    v_add_f32 v73, v73, v176
    v_mfma_f32_16x16x32_bf16 v[124:127], a[60:63], a[80:83], v[124:127]
    v_add_f32 v89, v89, v177
    v_mul_f32 v178, v204, v176
    v_mul_f32 v179, v204, v177
    v_fma_f32 v178, -v205, v177, v178
    v_fma_f32 v179, v205, v176, v179
    v_add_f32 v74, v74, v178
    v_add_f32 v90, v90, v179
    v_mfma_f32_16x16x32_bf16 v[128:131], a[64:67], a[68:71], v[128:131]
    buffer_load_dwordx4 a[48:51], v16, s[56:59], s16 offen offset:512 sc1
    v_mul_f32 v176, v204, v178
    v_mul_f32 v177, v204, v179
    v_fma_f32 v176, -v205, v179, v176
    v_fma_f32 v177, v205, v178, v177
    v_add_f32 v75, v75, v176
    v_add_f32 v91, v91, v177
    v_mul_f32 v178, v204, v176
    v_mfma_f32_16x16x32_bf16 v[132:135], a[64:67], a[72:75], v[132:135]
    v_mul_f32 v179, v204, v177
    v_fma_f32 v178, -v205, v177, v178
    v_fma_f32 v179, v205, v176, v179
    v_add_f32 v76, v76, v178
    v_add_f32 v92, v92, v179
    v_mul_f32 v176, v204, v178
    v_mul_f32 v177, v204, v179
    v_mfma_f32_16x16x32_bf16 v[136:139], a[64:67], a[76:79], v[136:139]
    buffer_load_dwordx4 a[52:55], v16, s[56:59], s16 offen offset:768 sc1
    s_add_u32 s16, s16, 32768
    s_add_u32 s17, s17, 89088
    v_fma_f32 v176, -v205, v179, v176
    v_fma_f32 v177, v205, v178, v177
    v_add_f32 v77, v77, v176
    v_add_f32 v93, v93, v177
    v_mul_f32 v178, v204, v176
    v_mul_f32 v179, v204, v177
    v_fma_f32 v178, -v205, v177, v178
    v_mfma_f32_16x16x32_bf16 v[140:143], a[64:67], a[80:83], v[140:143]
    v_fma_f32 v179, v205, v176, v179
    v_add_f32 v78, v78, v178
    v_add_f32 v94, v94, v179
    v_mul_f32 v176, v204, v178
    v_mul_f32 v177, v204, v179
    v_fma_f32 v176, -v205, v179, v176
    v_fma_f32 v177, v205, v178, v177
    s_waitcnt vmcnt(21)
    v_mfma_f32_16x16x32_bf16 v[96:99], a[84:87], a[96:99], v[96:99]
    buffer_load_dwordx4 a[56:59], v17, s[60:63], s17 offen offset:0 sc1
    v_add_f32 v79, v79, v176
    v_add_f32 v95, v95, v177
    v_cvt_pk_bf16_f32 v144, v64, v65
    v_cvt_pk_bf16_f32 v145, v66, v67
    v_cvt_pk_bf16_f32 v146, v68, v69
    v_cvt_pk_bf16_f32 v147, v70, v71
    v_cvt_pk_bf16_f32 v148, v72, v73
    v_mfma_f32_16x16x32_bf16 v[100:103], a[84:87], a[100:103], v[100:103]
    buffer_load_dwordx4 a[60:63], v17, s[60:63], s17 offen offset:256 sc1
    v_cvt_pk_bf16_f32 v149, v74, v75
    v_cvt_pk_bf16_f32 v150, v76, v77
    v_cvt_pk_bf16_f32 v151, v78, v79
    v_cvt_pk_bf16_f32 v152, -v80, -v81
    v_cvt_pk_bf16_f32 v153, -v82, -v83
    v_cvt_pk_bf16_f32 v154, -v84, -v85
    v_cvt_pk_bf16_f32 v155, -v86, -v87
    v_mfma_f32_16x16x32_bf16 v[104:107], a[84:87], a[104:107], v[104:107]
    v_cvt_pk_bf16_f32 v156, -v88, -v89
    v_cvt_pk_bf16_f32 v157, -v90, -v91
    v_cvt_pk_bf16_f32 v158, -v92, -v93
    v_cvt_pk_bf16_f32 v159, -v94, -v95
    v_mul_u32_u24 v30, 144, v2
    v_lshl_add_u32 v30, v3, 5, v30
    v_add_u32 v30, s12, v30
    v_mfma_f32_16x16x32_bf16 v[108:111], a[84:87], a[108:111], v[108:111]
    buffer_load_dwordx4 a[64:67], v239, s[60:63], s17 offen sc1
    ds_write_b128 v30, v[144:147] offset:2048
    ds_write_b128 v30, v[148:151] offset:2064
    ds_write_b128 v30, v[152:155] offset:4352
    ds_write_b128 v30, v[156:159] offset:4368
    v_mul_u32_u24 v31, 144, v29
    v_add_u32 v31, v31, v28
    v_add_u32 v31, s12, v31
    v_mfma_f32_16x16x32_bf16 v[112:115], a[88:91], a[96:99], v[112:115]
    ds_read_b64_tr_b16 v[160:161], v31 offset:2048
    ds_read_b64_tr_b16 v[162:163], v31 offset:2624
    ds_read_b64_tr_b16 v[164:165], v31 offset:3200
    ds_read_b64_tr_b16 v[166:167], v31 offset:3776
    ds_read_b64_tr_b16 v[168:169], v31 offset:4352
    ds_read_b64_tr_b16 v[170:171], v31 offset:4928
    ds_read_b64_tr_b16 v[172:173], v31 offset:5504
    v_mfma_f32_16x16x32_bf16 v[116:119], a[88:91], a[100:103], v[116:119]
    buffer_load_dwordx4 a[68:71], v16, s[56:59], s16 offen offset:0 sc1
    ds_read_b64_tr_b16 v[174:175], v31 offset:6080
    s_lshl_b32 s77, s23, 12
    s_lshl_b32 s78, s73, 10
    s_add_u32 s77, s77, s78
    s_waitcnt lgkmcnt(0)
    s_add_u32 s78, s77, 0
    buffer_store_dwordx4 v[160:163], v27, s[44:47], s78 offen sc1
    v_mfma_f32_16x16x32_bf16 v[120:123], a[88:91], a[104:107], v[120:123]
    buffer_load_dwordx4 a[72:75], v16, s[56:59], s16 offen offset:256 sc1
    s_add_u32 s78, s77, 32768
    buffer_store_dwordx4 v[164:167], v27, s[44:47], s78 offen sc1
    s_add_u32 s78, s77, 2097152
    buffer_store_dwordx4 v[168:171], v27, s[44:47], s78 offen sc1
    s_add_u32 s78, s77, 2129920
    buffer_store_dwordx4 v[172:175], v27, s[44:47], s78 offen sc1
    v_and_b32 v4, 31, v1
    v_mfma_f32_16x16x32_bf16 v[124:127], a[88:91], a[108:111], v[124:127]
    v_lshlrev_b32 v24, 4, v4
    v_lshrrev_b32 v5, 5, v1
    v_lshl_add_u32 v13, v5, 13, v24
    v_lshl_add_u32 v12, v5, 15, v24
    v_lshrrev_b32 v24, 3, v1
    v_mul_u32_u24 v6, 4096, v24
    v_bfe_u32 v24, v1, 4, 1
    v_mfma_f32_16x16x32_bf16 v[128:131], a[92:95], a[96:99], v[128:131]
    buffer_load_dwordx4 a[76:79], v16, s[56:59], s16 offen offset:512 sc1
    v_lshlrev_b32 v24, 2, v24
    v_and_b32 v25, 7, v1
    v_xor_b32 v24, v24, v25
    v_lshl_add_u32 v6, v24, 4, v6
    v_add_u32 v7, 31744, v6
    v_lshrrev_b32 v24, 5, v1
    v_bfe_u32 v25, v1, 2, 2
    v_mfma_f32_16x16x32_bf16 v[132:135], a[92:95], a[100:103], v[132:135]
    v_lshl_add_u32 v24, v24, 3, v25
    v_lshlrev_b32 v8, 7, v24
    v_and_b32 v24, 3, v1
    v_bfe_u32 v26, v1, 4, 1
    v_lshl_add_u32 v24, v26, 2, v24
    v_lshl_add_u32 v8, v24, 3, v8
    v_bfe_u32 v25, v1, 3, 1
    v_mfma_f32_16x16x32_bf16 v[136:139], a[92:95], a[104:107], v[136:139]
    buffer_load_dwordx4 a[80:83], v16, s[56:59], s16 offen offset:768 sc1
    s_add_u32 s16, s16, 32768
    s_add_u32 s17, s17, 89088
    v_lshlrev_b32 v25, 6, v25
    v_xor_b32 v8, v8, v25
    v_xor_b32 v9, 64, v8
    v_add_u32 v10, s25, v8
    v_add_u32 v11, s25, v9
    v_add_u32 v8, s24, v8
    v_add_u32 v9, s24, v9
    v_mfma_f32_16x16x32_bf16 v[140:143], a[92:95], a[108:111], v[140:143]
    v_bfe_u32 v24, v1, 1, 3
    v_xor_b32 v24, v24, v5
    v_lshlrev_b32 v24, 4, v24
    v_lshl_add_u32 v24, v4, 7, v24
    v_add_u32 v20, s24, v24
    v_add_u32 v32, s25, v24
    v_xor_b32 v21, 32, v20
    s_waitcnt vmcnt(25)
    v_mfma_f32_16x16x32_bf16 v[96:99], a[112:115], a[124:127], v[96:99]
    buffer_load_dwordx4 a[84:87], v17, s[60:63], s17 offen offset:0 sc1
    v_xor_b32 v33, 32, v32
    v_xor_b32 v22, 64, v20
    v_xor_b32 v34, 64, v32
    v_xor_b32 v23, 96, v20
    v_xor_b32 v35, 96, v32
    v_xor_b32 v24, v4, v5
    v_lshlrev_b32 v24, 4, v24
    v_mfma_f32_16x16x32_bf16 v[100:103], a[112:115], a[128:131], v[100:103]
    buffer_load_dwordx4 a[88:91], v17, s[60:63], s17 offen offset:256 sc1
    v_lshl_add_u32 v24, v5, 9, v24
    v_add_u32 v24, s24, v24
    v_xor_b32 v36, 0, v24
    v_xor_b32 v37, 32, v24
    v_xor_b32 v38, 64, v24
    v_xor_b32 v39, 96, v24
    v_xor_b32 v40, 128, v24
    v_mfma_f32_16x16x32_bf16 v[104:107], a[112:115], a[132:135], v[104:107]
    v_xor_b32 v41, 160, v24
    v_xor_b32 v42, 192, v24
    v_xor_b32 v43, 224, v24
    v_lshrrev_b32 v25, 3, v2
    v_lshlrev_b32 v25, 13, v25
    v_and_b32 v26, 7, v2
    v_lshl_add_u32 v25, v26, 9, v25
    v_mfma_f32_16x16x32_bf16 v[108:111], a[112:115], a[136:139], v[108:111]
    buffer_load_dwordx4 a[92:95], v239, s[60:63], s17 offen sc1
    s_lshr_b32 s77, s72, 1
    s_lshl_b32 s77, s77, 12
    s_and_b32 s78, s72, 1
    s_lshl_b32 s78, s78, 8
    s_add_u32 s77, s77, s78
    s_add_u32 s77, s77, 73728
    v_add_u32 v25, s77, v25
    v_mfma_f32_16x16x32_bf16 v[112:115], a[116:119], a[124:127], v[112:115]
    v_add_u32 v26, 0, v3
    v_xor_b32 v26, v26, v2
    v_lshl_add_u32 v64, v26, 4, v25
    v_add_u32 v68, 49152, v64
    v_add_u32 v26, 4, v3
    v_xor_b32 v26, v26, v2
    v_lshl_add_u32 v65, v26, 4, v25
    v_mfma_f32_16x16x32_bf16 v[116:119], a[116:119], a[128:131], v[116:119]
    buffer_load_dwordx4 a[96:99], v16, s[56:59], s16 offen offset:0 sc1
    v_add_u32 v69, 49152, v65
    v_add_u32 v26, 8, v3
    v_xor_b32 v26, v26, v2
    v_lshl_add_u32 v66, v26, 4, v25
    v_add_u32 v70, 49152, v66
    v_add_u32 v26, 12, v3
    v_xor_b32 v26, v26, v2
    v_mfma_f32_16x16x32_bf16 v[120:123], a[116:119], a[132:135], v[120:123]
    buffer_load_dwordx4 a[100:103], v16, s[56:59], s16 offen offset:256 sc1
    v_lshl_add_u32 v67, v26, 4, v25
    v_add_u32 v71, 49152, v67
    s_lshl_b32 s77, s73, 7
    s_lshr_b32 s78, s78, 2
    s_add_u32 s77, s77, s78
    v_lshlrev_b32 v18, 2, v2
    v_add_lshl_u32 v18, s77, v18, 5
    v_mfma_f32_16x16x32_bf16 v[124:127], a[116:119], a[136:139], v[124:127]
    s_mul_i32 s77, s72, 22
    v_min_u32 v19, 21, v4
    v_add_u32 v19, s77, v19
    v_min_u32 v19, 85, v19
    s_lshl_b32 s77, s74, 14
    v_lshlrev_b32 v19, 7, v19
    v_add_u32 v19, s77, v19
    v_mfma_f32_16x16x32_bf16 v[128:131], a[120:123], a[124:127], v[128:131]
    buffer_load_dwordx4 a[104:107], v16, s[56:59], s16 offen offset:512 sc1
    v_lshlrev_b32 v30, 4, v2
    v_lshl_add_u32 v30, v3, 10, v30
    v_add_u32 v30, s25, v30
    s_lshl_b32 s77, s72, 12
    v_add_u32 v31, s77, v27
    s_lshl_b32 s19, s72, 20
    s_lshl_b32 s77, s73, 10
    s_add_u32 s19, s19, s77
    v_mfma_f32_16x16x32_bf16 v[132:135], a[120:123], a[128:131], v[132:135]
    s_mul_i32 s20, s72, 360448
    s_lshl_b32 s77, s74, 10
    s_add_u32 s20, s20, s77
    s_mul_i32 s21, s72, 1441792
    s_lshl_b32 s77, s73, 7
    s_add_u32 s21, s21, s77
    s_mov_b32 s12, 327680
    s_mov_b32 s13, 196608
    s_barrier
    v_mfma_f32_16x16x32_bf16 v[136:139], a[120:123], a[132:135], v[136:139]
    buffer_load_dwordx4 a[108:111], v16, s[56:59], s16 offen offset:768 sc1
    s_add_u32 s16, s16, 32768
    s_add_u32 s17, s17, 89088
    v_mfma_f32_16x16x32_bf16 v[140:143], a[120:123], a[136:139], v[140:143]
    s_waitcnt vmcnt(25)
    v_mfma_f32_16x16x32_bf16 v[96:99], a[0:3], a[12:15], v[96:99]
    buffer_load_dwordx4 a[112:115], v17, s[60:63], s17 offen offset:0 sc1
    v_mfma_f32_16x16x32_bf16 v[100:103], a[0:3], a[16:19], v[100:103]
    buffer_load_dwordx4 a[116:119], v17, s[60:63], s17 offen offset:256 sc1
    v_mfma_f32_16x16x32_bf16 v[104:107], a[0:3], a[20:23], v[104:107]
    v_mfma_f32_16x16x32_bf16 v[108:111], a[0:3], a[24:27], v[108:111]
    buffer_load_dwordx4 a[120:123], v239, s[60:63], s17 offen sc1
    v_mfma_f32_16x16x32_bf16 v[112:115], a[4:7], a[12:15], v[112:115]
    v_mfma_f32_16x16x32_bf16 v[116:119], a[4:7], a[16:19], v[116:119]
    buffer_load_dwordx4 a[124:127], v16, s[56:59], s16 offen offset:0 sc1
    v_mfma_f32_16x16x32_bf16 v[120:123], a[4:7], a[20:23], v[120:123]
    buffer_load_dwordx4 a[128:131], v16, s[56:59], s16 offen offset:256 sc1
    v_mfma_f32_16x16x32_bf16 v[124:127], a[4:7], a[24:27], v[124:127]
    v_mfma_f32_16x16x32_bf16 v[128:131], a[8:11], a[12:15], v[128:131]
    buffer_load_dwordx4 a[132:135], v16, s[56:59], s16 offen offset:512 sc1
    v_mfma_f32_16x16x32_bf16 v[132:135], a[8:11], a[16:19], v[132:135]
    v_mfma_f32_16x16x32_bf16 v[136:139], a[8:11], a[20:23], v[136:139]
    buffer_load_dwordx4 a[136:139], v16, s[56:59], s16 offen offset:768 sc1
    s_add_u32 s16, s16, 32768
    s_add_u32 s17, s17, 89088
    v_mfma_f32_16x16x32_bf16 v[140:143], a[8:11], a[24:27], v[140:143]
    s_waitcnt vmcnt(25)
    v_mfma_f32_16x16x32_bf16 v[96:99], a[28:31], a[40:43], v[96:99]
    buffer_load_dwordx4 a[0:3], v17, s[60:63], s17 offen offset:0 sc1
    v_mfma_f32_16x16x32_bf16 v[100:103], a[28:31], a[44:47], v[100:103]
    buffer_load_dwordx4 a[4:7], v17, s[60:63], s17 offen offset:256 sc1
    v_mfma_f32_16x16x32_bf16 v[104:107], a[28:31], a[48:51], v[104:107]
    v_mfma_f32_16x16x32_bf16 v[108:111], a[28:31], a[52:55], v[108:111]
    buffer_load_dwordx4 a[8:11], v239, s[60:63], s17 offen sc1
    v_mfma_f32_16x16x32_bf16 v[112:115], a[32:35], a[40:43], v[112:115]
    v_mfma_f32_16x16x32_bf16 v[116:119], a[32:35], a[44:47], v[116:119]
    buffer_load_dwordx4 a[12:15], v16, s[56:59], s16 offen offset:0 sc1
    v_mfma_f32_16x16x32_bf16 v[120:123], a[32:35], a[48:51], v[120:123]
    buffer_load_dwordx4 a[16:19], v16, s[56:59], s16 offen offset:256 sc1
    v_mfma_f32_16x16x32_bf16 v[124:127], a[32:35], a[52:55], v[124:127]
    v_mfma_f32_16x16x32_bf16 v[128:131], a[36:39], a[40:43], v[128:131]
    buffer_load_dwordx4 a[20:23], v16, s[56:59], s16 offen offset:512 sc1
    v_mfma_f32_16x16x32_bf16 v[132:135], a[36:39], a[44:47], v[132:135]
    v_mfma_f32_16x16x32_bf16 v[136:139], a[36:39], a[48:51], v[136:139]
    buffer_load_dwordx4 a[24:27], v16, s[56:59], s16 offen offset:768 sc1
    s_add_u32 s16, s16, 32768
    s_add_u32 s17, s17, 89088
    v_mfma_f32_16x16x32_bf16 v[140:143], a[36:39], a[52:55], v[140:143]
    s_waitcnt vmcnt(21)
    s_waitcnt vmcnt(23)
    s_lshl_b32 s4, s73, 7
    s_lshl_b32 s5, s15, 2
    s_add_u32 s4, s4, s5
    s_lshl_b32 s4, s4, 5
    s_add_u32 s4, s4, 327680
    v_mov_b32 v251, 0
    s_mov_b64 exec, 1
    buffer_store_dword v236, v251, s[64:67], s4 offen sc1
    s_mov_b64 exec, -1
    v_mfma_f32_16x16x32_bf16 v[96:99], a[56:59], a[68:71], v[96:99]
    s_mov_b32 s52, s28
    s_and_b32 s53, s29, 0xffff
    s_mov_b32 s54, 5636096
    s_mov_b32 s55, 0x20000
    s_and_b32 s3, s74, 3
    s_lshl_b32 s3, s3, 2
    s_add_u32 s3, s3, s72
    s_mul_i32 s3, s3, 352256
    s_lshl_b32 s5, s73, 7
    s_add_u32 s3, s3, s5
    v_lshlrev_b32 v248, 12, v1
    v_min_u32 v249, 21, v1
    v_lshlrev_b32 v249, 12, v249
    s_add_u32 s5, s3, 262144
    buffer_load_dword v250, v248, s[52:55], s3 offen
    buffer_load_dword v250, v249, s[52:55], s5 offen
    v_mfma_f32_16x16x32_bf16 v[100:103], a[56:59], a[72:75], v[100:103]
    v_mfma_f32_16x16x32_bf16 v[104:107], a[56:59], a[76:79], v[104:107]
    v_mfma_f32_16x16x32_bf16 v[108:111], a[56:59], a[80:83], v[108:111]
    v_mfma_f32_16x16x32_bf16 v[112:115], a[60:63], a[68:71], v[112:115]
    v_mfma_f32_16x16x32_bf16 v[116:119], a[60:63], a[72:75], v[116:119]
    v_mfma_f32_16x16x32_bf16 v[120:123], a[60:63], a[76:79], v[120:123]
    v_mfma_f32_16x16x32_bf16 v[124:127], a[60:63], a[80:83], v[124:127]
    v_mfma_f32_16x16x32_bf16 v[128:131], a[64:67], a[68:71], v[128:131]
    v_mfma_f32_16x16x32_bf16 v[132:135], a[64:67], a[72:75], v[132:135]
    v_mfma_f32_16x16x32_bf16 v[136:139], a[64:67], a[76:79], v[136:139]
    v_mfma_f32_16x16x32_bf16 v[140:143], a[64:67], a[80:83], v[140:143]
    s_waitcnt vmcnt(17)
    v_mfma_f32_16x16x32_bf16 v[96:99], a[84:87], a[96:99], v[96:99]
    v_mfma_f32_16x16x32_bf16 v[100:103], a[84:87], a[100:103], v[100:103]
    v_mfma_f32_16x16x32_bf16 v[104:107], a[84:87], a[104:107], v[104:107]
    v_mfma_f32_16x16x32_bf16 v[108:111], a[84:87], a[108:111], v[108:111]
    v_mfma_f32_16x16x32_bf16 v[112:115], a[88:91], a[96:99], v[112:115]
    v_mfma_f32_16x16x32_bf16 v[116:119], a[88:91], a[100:103], v[116:119]
    v_mfma_f32_16x16x32_bf16 v[120:123], a[88:91], a[104:107], v[120:123]
    v_mfma_f32_16x16x32_bf16 v[124:127], a[88:91], a[108:111], v[124:127]
    v_mfma_f32_16x16x32_bf16 v[128:131], a[92:95], a[96:99], v[128:131]
    v_mfma_f32_16x16x32_bf16 v[132:135], a[92:95], a[100:103], v[132:135]
    v_mfma_f32_16x16x32_bf16 v[136:139], a[92:95], a[104:107], v[136:139]
    v_mfma_f32_16x16x32_bf16 v[140:143], a[92:95], a[108:111], v[140:143]
    s_waitcnt vmcnt(10)
    v_mfma_f32_16x16x32_bf16 v[96:99], a[112:115], a[124:127], v[96:99]
    v_mfma_f32_16x16x32_bf16 v[100:103], a[112:115], a[128:131], v[100:103]
    v_mfma_f32_16x16x32_bf16 v[104:107], a[112:115], a[132:135], v[104:107]
    v_mfma_f32_16x16x32_bf16 v[108:111], a[112:115], a[136:139], v[108:111]
    v_mfma_f32_16x16x32_bf16 v[112:115], a[116:119], a[124:127], v[112:115]
    v_mfma_f32_16x16x32_bf16 v[116:119], a[116:119], a[128:131], v[116:119]
    v_mfma_f32_16x16x32_bf16 v[120:123], a[116:119], a[132:135], v[120:123]
    v_mfma_f32_16x16x32_bf16 v[124:127], a[116:119], a[136:139], v[124:127]
    v_mfma_f32_16x16x32_bf16 v[128:131], a[120:123], a[124:127], v[128:131]
    v_mfma_f32_16x16x32_bf16 v[132:135], a[120:123], a[128:131], v[132:135]
    v_mfma_f32_16x16x32_bf16 v[136:139], a[120:123], a[132:135], v[136:139]
    v_mfma_f32_16x16x32_bf16 v[140:143], a[120:123], a[136:139], v[140:143]
    s_waitcnt vmcnt(3)
    v_mfma_f32_16x16x32_bf16 v[96:99], a[0:3], a[12:15], v[96:99]
    v_mfma_f32_16x16x32_bf16 v[100:103], a[0:3], a[16:19], v[100:103]
    v_mfma_f32_16x16x32_bf16 v[104:107], a[0:3], a[20:23], v[104:107]
    v_mfma_f32_16x16x32_bf16 v[108:111], a[0:3], a[24:27], v[108:111]
    v_mfma_f32_16x16x32_bf16 v[112:115], a[4:7], a[12:15], v[112:115]
    v_mfma_f32_16x16x32_bf16 v[116:119], a[4:7], a[16:19], v[116:119]
    v_mfma_f32_16x16x32_bf16 v[120:123], a[4:7], a[20:23], v[120:123]
    v_mfma_f32_16x16x32_bf16 v[124:127], a[4:7], a[24:27], v[124:127]
    v_mfma_f32_16x16x32_bf16 v[128:131], a[8:11], a[12:15], v[128:131]
    v_mfma_f32_16x16x32_bf16 v[132:135], a[8:11], a[16:19], v[132:135]
    v_mfma_f32_16x16x32_bf16 v[136:139], a[8:11], a[20:23], v[136:139]
    v_mfma_f32_16x16x32_bf16 v[140:143], a[8:11], a[24:27], v[140:143]
    ds_write_b128 v30, v[96:99] offset:0
    ds_write_b128 v30, v[100:103] offset:256
    ds_write_b128 v30, v[104:107] offset:512
    ds_write_b128 v30, v[108:111] offset:768
    ds_write_b128 v30, v[112:115] offset:4096
    ds_write_b128 v30, v[116:119] offset:4352
    ds_write_b128 v30, v[120:123] offset:4608
    ds_write_b128 v30, v[124:127] offset:4864
    ds_write_b128 v30, v[128:131] offset:8192
    ds_write_b128 v30, v[132:135] offset:8448
    ds_write_b128 v30, v[136:139] offset:8704
    ds_write_b128 v30, v[140:143] offset:8960
    s_waitcnt lgkmcnt(0)
    s_barrier
    s_cmp_eq_u32 s72, 3
    s_cbranch_scc1 kw3
    ds_read_b128 v[144:147], v31 offset:0
    ds_read_b128 v[148:151], v31 offset:1024
    ds_read_b128 v[152:155], v31 offset:2048
    ds_read_b128 v[156:159], v31 offset:3072
    ds_read_b128 v[160:163], v31 offset:16384
    ds_read_b128 v[164:167], v31 offset:17408
    ds_read_b128 v[168:171], v31 offset:18432
    ds_read_b128 v[172:175], v31 offset:19456
    ds_read_b128 v[176:179], v31 offset:32768
    ds_read_b128 v[180:183], v31 offset:33792
    ds_read_b128 v[184:187], v31 offset:34816
    ds_read_b128 v[188:191], v31 offset:35840
    ds_read_b128 v[192:195], v31 offset:49152
    ds_read_b128 v[196:199], v31 offset:50176
    ds_read_b128 v[200:203], v31 offset:51200
    ds_read_b128 v[204:207], v31 offset:52224
    s_waitcnt lgkmcnt(0)
    s_barrier
    v_pk_add_f32 v[144:145], v[144:145], v[160:161]
    v_pk_add_f32 v[146:147], v[146:147], v[162:163]
    v_pk_add_f32 v[148:149], v[148:149], v[164:165]
    v_pk_add_f32 v[150:151], v[150:151], v[166:167]
    v_pk_add_f32 v[152:153], v[152:153], v[168:169]
    v_pk_add_f32 v[154:155], v[154:155], v[170:171]
    v_pk_add_f32 v[156:157], v[156:157], v[172:173]
    v_pk_add_f32 v[158:159], v[158:159], v[174:175]
    v_pk_add_f32 v[176:177], v[176:177], v[192:193]
    v_pk_add_f32 v[178:179], v[178:179], v[194:195]
    v_pk_add_f32 v[180:181], v[180:181], v[196:197]
    s_add_u32 m0, s25, 0
    s_add_u32 s5, s14, 128
    buffer_load_dwordx4 v14, s[68:71], s5 offen lds
    v_pk_add_f32 v[182:183], v[182:183], v[198:199]
    v_pk_add_f32 v[184:185], v[184:185], v[200:201]
    v_pk_add_f32 v[186:187], v[186:187], v[202:203]
    v_pk_add_f32 v[188:189], v[188:189], v[204:205]
    v_pk_add_f32 v[190:191], v[190:191], v[206:207]
    v_pk_add_f32 v[144:145], v[144:145], v[176:177]
    v_pk_add_f32 v[146:147], v[146:147], v[178:179]
    v_pk_add_f32 v[148:149], v[148:149], v[180:181]
    v_pk_add_f32 v[150:151], v[150:151], v[182:183]
    v_pk_add_f32 v[152:153], v[152:153], v[184:185]
    v_pk_add_f32 v[154:155], v[154:155], v[186:187]
    buffer_load_dwordx4 v15, s[68:71], s5 offen offset:1024 lds
    v_pk_add_f32 v[156:157], v[156:157], v[188:189]
    v_pk_add_f32 v[158:159], v[158:159], v[190:191]
    v_cvt_pk_bf16_f32 v96, v144, v145
    v_cvt_pk_bf16_f32 v97, v146, v147
    v_cvt_pk_bf16_f32 v98, v148, v149
    v_cvt_pk_bf16_f32 v99, v150, v151
    v_cvt_pk_bf16_f32 v100, v152, v153
    v_cvt_pk_bf16_f32 v101, v154, v155
    v_cvt_pk_bf16_f32 v102, v156, v157
    v_cvt_pk_bf16_f32 v103, v158, v159
    v_lshlrev_b32 v144, 16, v96
    s_add_u32 m0, s25, 2048
    s_add_u32 s5, s14, 16512
    buffer_load_dwordx4 v14, s[68:71], s5 offen lds
    v_and_b32 v145, 0xffff0000, v96
    v_lshlrev_b32 v146, 16, v97
    v_and_b32 v147, 0xffff0000, v97
    v_lshlrev_b32 v148, 16, v98
    v_and_b32 v149, 0xffff0000, v98
    v_lshlrev_b32 v150, 16, v99
    v_and_b32 v151, 0xffff0000, v99
    v_lshlrev_b32 v152, 16, v100
    v_and_b32 v153, 0xffff0000, v100
    v_lshlrev_b32 v154, 16, v101
    v_and_b32 v155, 0xffff0000, v101
    buffer_load_dwordx4 v15, s[68:71], s5 offen offset:1024 lds
    v_lshlrev_b32 v156, 16, v102
    v_and_b32 v157, 0xffff0000, v102
    v_lshlrev_b32 v158, 16, v103
    v_and_b32 v159, 0xffff0000, v103
    s_lshl_b32 s77, s80, 16
    s_and_b32 s78, s80, 0xffff0000
    v_add_f32 v144, s77, v144
    v_add_f32 v145, s78, v145
    s_lshl_b32 s77, s81, 16
    s_and_b32 s78, s81, 0xffff0000
    v_add_f32 v146, s77, v146
    v_add_f32 v147, s78, v147
    s_add_u32 m0, s25, 4096
    s_add_u32 s5, s14, 32896
    buffer_load_dwordx4 v14, s[68:71], s5 offen lds
    s_lshl_b32 s77, s82, 16
    s_and_b32 s78, s82, 0xffff0000
    v_add_f32 v148, s77, v148
    v_add_f32 v149, s78, v149
    s_lshl_b32 s77, s83, 16
    s_and_b32 s78, s83, 0xffff0000
    v_add_f32 v150, s77, v150
    v_add_f32 v151, s78, v151
    s_lshl_b32 s77, s84, 16
    s_and_b32 s78, s84, 0xffff0000
    v_add_f32 v152, s77, v152
    v_add_f32 v153, s78, v153
    buffer_load_dwordx4 v15, s[68:71], s5 offen offset:1024 lds
    s_lshl_b32 s77, s85, 16
    s_and_b32 s78, s85, 0xffff0000
    v_add_f32 v154, s77, v154
    v_add_f32 v155, s78, v155
    s_lshl_b32 s77, s86, 16
    s_and_b32 s78, s86, 0xffff0000
    v_add_f32 v156, s77, v156
    v_add_f32 v157, s78, v157
    s_lshl_b32 s77, s87, 16
    s_and_b32 s78, s87, 0xffff0000
    v_add_f32 v158, s77, v158
    v_add_f32 v159, s78, v159
    s_add_u32 m0, s25, 6144
    s_add_u32 s5, s14, 49280
    buffer_load_dwordx4 v14, s[68:71], s5 offen lds
    v_cvt_pk_bf16_f32 v96, v144, v145
    v_cvt_pk_bf16_f32 v97, v146, v147
    v_cvt_pk_bf16_f32 v98, v148, v149
    v_cvt_pk_bf16_f32 v99, v150, v151
    v_cvt_pk_bf16_f32 v100, v152, v153
    v_cvt_pk_bf16_f32 v101, v154, v155
    v_cvt_pk_bf16_f32 v102, v156, v157
    v_cvt_pk_bf16_f32 v103, v158, v159
    v_lshlrev_b32 v144, 16, v96
    v_and_b32 v145, 0xffff0000, v96
    v_lshlrev_b32 v146, 16, v97
    buffer_load_dwordx4 v15, s[68:71], s5 offen offset:1024 lds
    v_and_b32 v147, 0xffff0000, v97
    v_lshlrev_b32 v148, 16, v98
    v_and_b32 v149, 0xffff0000, v98
    v_lshlrev_b32 v150, 16, v99
    v_and_b32 v151, 0xffff0000, v99
    v_lshlrev_b32 v152, 16, v100
    v_and_b32 v153, 0xffff0000, v100
    v_lshlrev_b32 v154, 16, v101
    v_and_b32 v155, 0xffff0000, v101
    v_lshlrev_b32 v156, 16, v102
    v_and_b32 v157, 0xffff0000, v102
    s_add_u32 m0, s25, 8192
    s_nop 0
    buffer_load_dwordx4 v6, s[52:55], s21 offen lds
    v_lshlrev_b32 v158, 16, v103
    v_and_b32 v159, 0xffff0000, v103
    v_mov_b32 v24, 0xc0135761
    v_pk_mul_f32 v[160:161], v[144:145], v[144:145]
    v_pk_mul_f32 v[162:163], v[146:147], v[146:147]
    v_pk_mul_f32 v[164:165], v[148:149], v[148:149]
    v_pk_mul_f32 v[166:167], v[150:151], v[150:151]
    v_pk_mul_f32 v[168:169], v[152:153], v[152:153]
    v_pk_mul_f32 v[170:171], v[154:155], v[154:155]
    v_pk_mul_f32 v[172:173], v[156:157], v[156:157]
    v_pk_mul_f32 v[174:175], v[158:159], v[158:159]
    buffer_load_dwordx4 v7, s[52:55], s21 offen offset:1024 lds
    s_add_u32 s21, s21, 65536
    v_fmamk_f32 v160, v160, 0xbdd2d3e8, v24
    v_fmamk_f32 v161, v161, 0xbdd2d3e8, v24
    v_fmamk_f32 v162, v162, 0xbdd2d3e8, v24
    v_fmamk_f32 v163, v163, 0xbdd2d3e8, v24
    v_fmamk_f32 v164, v164, 0xbdd2d3e8, v24
    v_fmamk_f32 v165, v165, 0xbdd2d3e8, v24
    v_fmamk_f32 v166, v166, 0xbdd2d3e8, v24
    v_fmamk_f32 v167, v167, 0xbdd2d3e8, v24
    v_fmamk_f32 v168, v168, 0xbdd2d3e8, v24
    v_fmamk_f32 v169, v169, 0xbdd2d3e8, v24
    v_fmamk_f32 v170, v170, 0xbdd2d3e8, v24
    buffer_load_dword v238, v18, s[64:67], s12 offen sc1
    v_fmamk_f32 v171, v171, 0xbdd2d3e8, v24
    v_fmamk_f32 v172, v172, 0xbdd2d3e8, v24
    v_fmamk_f32 v173, v173, 0xbdd2d3e8, v24
    v_fmamk_f32 v174, v174, 0xbdd2d3e8, v24
    v_fmamk_f32 v175, v175, 0xbdd2d3e8, v24
    v_pk_mul_f32 v[160:161], v[160:161], v[144:145]
    v_pk_mul_f32 v[162:163], v[162:163], v[146:147]
    v_pk_mul_f32 v[164:165], v[164:165], v[148:149]
    v_pk_mul_f32 v[166:167], v[166:167], v[150:151]
    v_pk_mul_f32 v[168:169], v[168:169], v[152:153]
    v_pk_mul_f32 v[170:171], v[170:171], v[154:155]
    s_add_u32 m0, s25, 10240
    s_nop 0
    buffer_load_dwordx4 v6, s[52:55], s21 offen lds
    v_pk_mul_f32 v[172:173], v[172:173], v[156:157]
    v_pk_mul_f32 v[174:175], v[174:175], v[158:159]
    v_exp_f32 v160, v160
    v_exp_f32 v161, v161
    v_exp_f32 v162, v162
    v_exp_f32 v163, v163
    v_exp_f32 v164, v164
    v_exp_f32 v165, v165
    v_exp_f32 v166, v166
    v_exp_f32 v167, v167
    v_exp_f32 v168, v168
    buffer_load_dwordx4 v7, s[52:55], s21 offen offset:1024 lds
    s_add_u32 s21, s21, 65536
    v_exp_f32 v169, v169
    v_exp_f32 v170, v170
    v_exp_f32 v171, v171
    v_exp_f32 v172, v172
    v_exp_f32 v173, v173
    v_exp_f32 v174, v174
    v_exp_f32 v175, v175
    v_add_f32 v160, 1.0, v160
    v_add_f32 v161, 1.0, v161
    v_add_f32 v162, 1.0, v162
    v_add_f32 v163, 1.0, v163
    s_add_u32 m0, s25, 12288
    s_nop 0
    buffer_load_dwordx4 v6, s[52:55], s21 offen lds
    v_add_f32 v164, 1.0, v164
    v_add_f32 v165, 1.0, v165
    v_add_f32 v166, 1.0, v166
    v_add_f32 v167, 1.0, v167
    v_add_f32 v168, 1.0, v168
    v_add_f32 v169, 1.0, v169
    v_add_f32 v170, 1.0, v170
    v_add_f32 v171, 1.0, v171
    v_add_f32 v172, 1.0, v172
    v_add_f32 v173, 1.0, v173
    v_add_f32 v174, 1.0, v174
    buffer_load_dwordx4 v7, s[52:55], s21 offen offset:1024 lds
    s_add_u32 s21, s21, 65536
    v_add_f32 v175, 1.0, v175
    v_rcp_f32 v160, v160
    v_rcp_f32 v161, v161
    v_rcp_f32 v162, v162
    v_rcp_f32 v163, v163
    v_rcp_f32 v164, v164
    v_rcp_f32 v165, v165
    v_rcp_f32 v166, v166
    v_rcp_f32 v167, v167
    v_rcp_f32 v168, v168
    v_rcp_f32 v169, v169
    s_add_u32 m0, s25, 14336
    s_nop 0
    buffer_load_dwordx4 v6, s[52:55], s21 offen lds
    v_rcp_f32 v170, v170
    v_rcp_f32 v171, v171
    v_rcp_f32 v172, v172
    v_rcp_f32 v173, v173
    v_rcp_f32 v174, v174
    v_rcp_f32 v175, v175
    v_pk_mul_f32 v[160:161], v[160:161], v[144:145]
    v_pk_mul_f32 v[162:163], v[162:163], v[146:147]
    v_pk_mul_f32 v[164:165], v[164:165], v[148:149]
    v_pk_mul_f32 v[166:167], v[166:167], v[150:151]
    v_pk_mul_f32 v[168:169], v[168:169], v[152:153]
    buffer_load_dwordx4 v7, s[52:55], s21 offen offset:1024 lds
    s_add_u32 s21, s21, 65536
    v_pk_mul_f32 v[170:171], v[170:171], v[154:155]
    v_pk_mul_f32 v[172:173], v[172:173], v[156:157]
    v_pk_mul_f32 v[174:175], v[174:175], v[158:159]
    v_cvt_pk_bf16_f32 v96, v160, v161
    v_cvt_pk_bf16_f32 v97, v162, v163
    v_cvt_pk_bf16_f32 v98, v164, v165
    v_cvt_pk_bf16_f32 v99, v166, v167
    v_cvt_pk_bf16_f32 v100, v168, v169
    v_cvt_pk_bf16_f32 v101, v170, v171
    v_cvt_pk_bf16_f32 v102, v172, v173
    v_cvt_pk_bf16_f32 v103, v174, v175
    s_lshl_b32 s77, s18, 9
    s_lshl_b32 s78, s76, 10
    s_add_u32 s77, s77, s78
    s_cmp_lt_u32 s2, 232
    s_cselect_b32 s77, s77, 0x1000000
    s_add_u32 s78, s77, 8192
    buffer_store_dwordx4 v[96:99], v27, s[48:51], s77 offen sc1
    buffer_store_dwordx4 v[100:103], v27, s[48:51], s78 offen sc1
    s_branch kj1
kw3:
    s_barrier
    s_add_u32 m0, s25, 0
    s_add_u32 s5, s14, 128
    buffer_load_dwordx4 v14, s[68:71], s5 offen lds
    buffer_load_dwordx4 v15, s[68:71], s5 offen offset:1024 lds
    s_add_u32 m0, s25, 2048
    s_add_u32 s5, s14, 16512
    buffer_load_dwordx4 v14, s[68:71], s5 offen lds
    buffer_load_dwordx4 v15, s[68:71], s5 offen offset:1024 lds
    s_add_u32 m0, s25, 4096
    s_add_u32 s5, s14, 32896
    buffer_load_dwordx4 v14, s[68:71], s5 offen lds
    buffer_load_dwordx4 v15, s[68:71], s5 offen offset:1024 lds
    s_add_u32 m0, s25, 6144
    s_add_u32 s5, s14, 49280
    buffer_load_dwordx4 v14, s[68:71], s5 offen lds
    buffer_load_dwordx4 v15, s[68:71], s5 offen offset:1024 lds
    s_add_u32 m0, s25, 8192
    s_nop 0
    buffer_load_dwordx4 v6, s[52:55], s21 offen lds
    buffer_load_dwordx4 v7, s[52:55], s21 offen offset:1024 lds
    s_add_u32 s21, s21, 65536
    s_add_u32 m0, s25, 10240
    s_nop 0
    buffer_load_dwordx4 v6, s[52:55], s21 offen lds
    buffer_load_dwordx4 v7, s[52:55], s21 offen offset:1024 lds
    s_add_u32 s21, s21, 65536
    s_add_u32 m0, s25, 12288
    s_nop 0
    buffer_load_dwordx4 v6, s[52:55], s21 offen lds
    buffer_load_dwordx4 v7, s[52:55], s21 offen offset:1024 lds
    s_add_u32 s21, s21, 65536
    s_add_u32 m0, s25, 14336
    s_nop 0
    buffer_load_dwordx4 v6, s[52:55], s21 offen lds
    buffer_load_dwordx4 v7, s[52:55], s21 offen offset:1024 lds
    s_add_u32 s21, s21, 65536
    s_sleep 8
    buffer_load_dword v238, v18, s[64:67], s12 offen sc1
    s_waitcnt vmcnt(0)
    s_cmp_lg_u32 s2, 0
    s_cbranch_scc1 kj1
    v_add_u32 v24, 1, v237
    v_mov_b32 v25, 49152
    s_mov_b64 exec, 1
    buffer_store_dword v24, v25, s[64:67], 0 offen sc1
    s_mov_b64 exec, -1
kj1:
    s_waitcnt vmcnt(6)
    v_cmp_ne_u32 s[10:11], v238, v236
    s_nop 1
    s_cmp_eq_u64 s[10:11], 0
    s_cselect_b32 s46, 4194304, 0
    buffer_load_dwordx4 a[0:3], v12, s[44:47], s19 offen offset:0 sc1
    buffer_load_dwordx4 a[4:7], v12, s[44:47], s19 offen offset:512 sc1
    s_add_u32 s19, s19, 65536
    buffer_load_dwordx4 a[8:11], v12, s[44:47], s19 offen offset:0 sc1
    buffer_load_dwordx4 a[12:15], v12, s[44:47], s19 offen offset:512 sc1
    s_add_u32 s19, s19, 65536
    buffer_load_dwordx4 a[16:19], v12, s[44:47], s19 offen offset:0 sc1
    buffer_load_dwordx4 a[20:23], v12, s[44:47], s19 offen offset:512 sc1
    s_add_u32 s19, s19, 65536
    buffer_load_dwordx4 a[24:27], v12, s[44:47], s19 offen offset:0 sc1
    buffer_load_dwordx4 a[28:31], v12, s[44:47], s19 offen offset:512 sc1
    s_add_u32 s19, s19, 65536
    buffer_load_dwordx4 a[32:35], v12, s[44:47], s19 offen offset:0 sc1
    buffer_load_dwordx4 a[36:39], v12, s[44:47], s19 offen offset:512 sc1
    s_add_u32 s19, s19, 65536
    buffer_load_dwordx4 a[40:43], v12, s[44:47], s19 offen offset:0 sc1
    buffer_load_dwordx4 a[44:47], v12, s[44:47], s19 offen offset:512 sc1
    s_add_u32 s19, s19, 65536
    s_waitcnt vmcnt(12)
    s_lshr_b32 s77, s18, 3
    s_lshl_b32 s78, s76, 9
    s_add_u32 s77, s77, s78
    s_lshl_b32 s77, s77, 5
    s_add_u32 s77, s77, 196608
    s_cmp_lt_u32 s2, 232
    s_cselect_b32 s77, s77, 0x1000000
    s_cmp_lt_u32 s72, 3
    s_cselect_b32 s77, s77, 0x1000000
    v_mov_b32 v24, 0
    s_mov_b64 exec, 1
    buffer_store_dword v236, v24, s[64:67], s77 offen sc1
    s_mov_b64 exec, -1
    s_cmp_eq_u64 s[10:11], 0
    s_cbranch_scc1 khd
    v_cmp_ne_u32 s[6:7], v238, v236
    s_nop 1
    s_cmp_eq_u64 s[6:7], 0
    s_cbranch_scc1 kp2_ok
    s_mov_b32 s3, 0
kp2_lp:
    s_sleep 1
    buffer_load_dword v238, v18, s[64:67], s12 offen sc1
    s_waitcnt vmcnt(0)
    v_cmp_ne_u32 s[6:7], v238, v236
    s_add_u32 s3, s3, 1
    s_nop 0
    s_cmp_eq_u64 s[6:7], 0
    s_cbranch_scc1 kp2_ok
    s_cmp_lt_u32 s3, 200000
    s_cbranch_scc1 kp2_lp
kp2_ok:
    s_mov_b32 s46, 4194304
    s_sub_u32 s19, s19, 393216
    buffer_load_dwordx4 a[0:3], v12, s[44:47], s19 offen offset:0 sc1
    buffer_load_dwordx4 a[4:7], v12, s[44:47], s19 offen offset:512 sc1
    s_add_u32 s19, s19, 65536
    buffer_load_dwordx4 a[8:11], v12, s[44:47], s19 offen offset:0 sc1
    buffer_load_dwordx4 a[12:15], v12, s[44:47], s19 offen offset:512 sc1
    s_add_u32 s19, s19, 65536
    buffer_load_dwordx4 a[16:19], v12, s[44:47], s19 offen offset:0 sc1
    buffer_load_dwordx4 a[20:23], v12, s[44:47], s19 offen offset:512 sc1
    s_add_u32 s19, s19, 65536
    buffer_load_dwordx4 a[24:27], v12, s[44:47], s19 offen offset:0 sc1
    buffer_load_dwordx4 a[28:31], v12, s[44:47], s19 offen offset:512 sc1
    s_add_u32 s19, s19, 65536
    buffer_load_dwordx4 a[32:35], v12, s[44:47], s19 offen offset:0 sc1
    buffer_load_dwordx4 a[36:39], v12, s[44:47], s19 offen offset:512 sc1
    s_add_u32 s19, s19, 65536
    buffer_load_dwordx4 a[40:43], v12, s[44:47], s19 offen offset:0 sc1
    buffer_load_dwordx4 a[44:47], v12, s[44:47], s19 offen offset:512 sc1
    s_add_u32 s19, s19, 65536
khd:
    ds_read_b128 v[48:51], v20 offset:0
    ds_read_b128 v[52:55], v20 offset:4096
    s_waitcnt vmcnt(10)
    ds_read_b128 v[56:59], v21 offset:0
    ds_read_b128 v[60:63], v21 offset:4096
    s_waitcnt lgkmcnt(2)
    v_mfma_f32_32x32x16_bf16 a[128:143], v[48:51], a[0:3], 0
    buffer_load_dwordx4 a[48:51], v12, s[44:47], s19 offen offset:0 sc1
    v_mfma_f32_32x32x16_bf16 a[144:159], v[48:51], a[4:7], 0
    buffer_load_dwordx4 a[52:55], v12, s[44:47], s19 offen offset:512 sc1
    s_add_u32 s19, s19, 65536
    v_mfma_f32_32x32x16_bf16 a[160:175], v[52:55], a[0:3], 0
    buffer_load_dwordx4 a[56:59], v12, s[44:47], s19 offen offset:0 sc1
    v_mfma_f32_32x32x16_bf16 a[176:191], v[52:55], a[4:7], 0
    s_waitcnt vmcnt(11)
    ds_read_b128 v[48:51], v22 offset:0
    ds_read_b128 v[52:55], v22 offset:4096
    s_waitcnt lgkmcnt(2)
    v_mfma_f32_32x32x16_bf16 a[128:143], v[56:59], a[8:11], a[128:143]
    buffer_load_dwordx4 a[60:63], v12, s[44:47], s19 offen offset:512 sc1
    s_add_u32 s19, s19, 65536
    v_mfma_f32_32x32x16_bf16 a[144:159], v[56:59], a[12:15], a[144:159]
    buffer_load_dwordx4 a[64:67], v12, s[44:47], s19 offen offset:0 sc1
    v_mfma_f32_32x32x16_bf16 a[160:175], v[60:63], a[8:11], a[160:175]
    buffer_load_dwordx4 a[68:71], v12, s[44:47], s19 offen offset:512 sc1
    s_add_u32 s19, s19, 65536
    v_mfma_f32_32x32x16_bf16 a[176:191], v[60:63], a[12:15], a[176:191]
    s_waitcnt vmcnt(12)
    ds_read_b128 v[56:59], v23 offset:0
    ds_read_b128 v[60:63], v23 offset:4096
    s_waitcnt lgkmcnt(2)
    v_mfma_f32_32x32x16_bf16 a[128:143], v[48:51], a[16:19], a[128:143]
    buffer_load_dwordx4 a[72:75], v12, s[44:47], s19 offen offset:0 sc1
    v_mfma_f32_32x32x16_bf16 a[144:159], v[48:51], a[20:23], a[144:159]
    buffer_load_dwordx4 a[76:79], v12, s[44:47], s19 offen offset:512 sc1
    s_add_u32 s19, s19, 65536
    v_mfma_f32_32x32x16_bf16 a[160:175], v[52:55], a[16:19], a[160:175]
    buffer_load_dwordx4 a[80:83], v12, s[44:47], s19 offen offset:0 sc1
    v_mfma_f32_32x32x16_bf16 a[176:191], v[52:55], a[20:23], a[176:191]
    s_waitcnt vmcnt(13)
    ds_read_b128 v[48:51], v32 offset:0
    ds_read_b128 v[52:55], v32 offset:4096
    s_waitcnt lgkmcnt(2)
    v_mfma_f32_32x32x16_bf16 a[128:143], v[56:59], a[24:27], a[128:143]
    buffer_load_dwordx4 a[84:87], v12, s[44:47], s19 offen offset:512 sc1
    s_add_u32 s19, s19, 65536
    v_mfma_f32_32x32x16_bf16 a[144:159], v[56:59], a[28:31], a[144:159]
    buffer_load_dwordx4 a[88:91], v12, s[44:47], s19 offen offset:0 sc1
    v_mfma_f32_32x32x16_bf16 a[160:175], v[60:63], a[24:27], a[160:175]
    buffer_load_dwordx4 a[92:95], v12, s[44:47], s19 offen offset:512 sc1
    s_add_u32 s19, s19, 65536
    v_mfma_f32_32x32x16_bf16 a[176:191], v[60:63], a[28:31], a[176:191]
    s_waitcnt vmcnt(14)
    ds_read_b128 v[56:59], v33 offset:0
    ds_read_b128 v[60:63], v33 offset:4096
    s_waitcnt lgkmcnt(2)
    v_mfma_f32_32x32x16_bf16 a[128:143], v[48:51], a[32:35], a[128:143]
    buffer_load_dwordx4 a[96:99], v12, s[44:47], s19 offen offset:0 sc1
    v_mfma_f32_32x32x16_bf16 a[144:159], v[48:51], a[36:39], a[144:159]
    buffer_load_dwordx4 a[100:103], v12, s[44:47], s19 offen offset:512 sc1
    s_add_u32 s19, s19, 65536
    v_mfma_f32_32x32x16_bf16 a[160:175], v[52:55], a[32:35], a[160:175]
    buffer_load_dwordx4 a[104:107], v12, s[44:47], s19 offen offset:0 sc1
    v_mfma_f32_32x32x16_bf16 a[176:191], v[52:55], a[36:39], a[176:191]
    s_waitcnt vmcnt(15)
    ds_read_b128 v[48:51], v34 offset:0
    ds_read_b128 v[52:55], v34 offset:4096
    s_waitcnt lgkmcnt(2)
    v_mfma_f32_32x32x16_bf16 a[128:143], v[56:59], a[40:43], a[128:143]
    buffer_load_dwordx4 a[108:111], v12, s[44:47], s19 offen offset:512 sc1
    s_add_u32 s19, s19, 65536
    v_mfma_f32_32x32x16_bf16 a[144:159], v[56:59], a[44:47], a[144:159]
    buffer_load_dwordx4 a[112:115], v12, s[44:47], s19 offen offset:0 sc1
    v_mfma_f32_32x32x16_bf16 a[160:175], v[60:63], a[40:43], a[160:175]
    buffer_load_dwordx4 a[116:119], v12, s[44:47], s19 offen offset:512 sc1
    s_add_u32 s19, s19, 65536
    v_mfma_f32_32x32x16_bf16 a[176:191], v[60:63], a[44:47], a[176:191]
    s_waitcnt vmcnt(16)
    ds_read_b128 v[56:59], v35 offset:0
    ds_read_b128 v[60:63], v35 offset:4096
    s_waitcnt lgkmcnt(2)
    v_mfma_f32_32x32x16_bf16 a[128:143], v[48:51], a[48:51], a[128:143]
    buffer_load_dwordx4 a[120:123], v12, s[44:47], s19 offen offset:0 sc1
    v_mfma_f32_32x32x16_bf16 a[144:159], v[48:51], a[52:55], a[144:159]
    buffer_load_dwordx4 a[124:127], v12, s[44:47], s19 offen offset:512 sc1
    s_add_u32 s19, s19, 65536
    v_mfma_f32_32x32x16_bf16 a[160:175], v[52:55], a[48:51], a[160:175]
    s_add_u32 m0, s24, 0
    s_nop 0
    buffer_load_dwordx4 v6, s[52:55], s21 offen lds
    v_mfma_f32_32x32x16_bf16 a[176:191], v[52:55], a[52:55], a[176:191]
    s_waitcnt vmcnt(17)
    ds_read_b128 v[48:51], v20 offset:8192
    ds_read_b128 v[52:55], v20 offset:12288
    s_waitcnt lgkmcnt(2)
    v_mfma_f32_32x32x16_bf16 a[128:143], v[56:59], a[56:59], a[128:143]
    buffer_load_dwordx4 v7, s[52:55], s21 offen offset:1024 lds
    s_add_u32 s21, s21, 65536
    v_mfma_f32_32x32x16_bf16 a[144:159], v[56:59], a[60:63], a[144:159]
    s_add_u32 m0, s24, 2048
    s_nop 0
    buffer_load_dwordx4 v6, s[52:55], s21 offen lds
    v_mfma_f32_32x32x16_bf16 a[160:175], v[60:63], a[56:59], a[160:175]
    buffer_load_dwordx4 v7, s[52:55], s21 offen offset:1024 lds
    s_add_u32 s21, s21, 65536
    v_mfma_f32_32x32x16_bf16 a[176:191], v[60:63], a[60:63], a[176:191]
    s_waitcnt vmcnt(18)
    ds_read_b128 v[56:59], v21 offset:8192
    ds_read_b128 v[60:63], v21 offset:12288
    s_waitcnt lgkmcnt(2)
    v_mfma_f32_32x32x16_bf16 a[128:143], v[48:51], a[64:67], a[128:143]
    s_add_u32 m0, s24, 4096
    s_nop 0
    buffer_load_dwordx4 v6, s[52:55], s21 offen lds
    v_mfma_f32_32x32x16_bf16 a[144:159], v[48:51], a[68:71], a[144:159]
    buffer_load_dwordx4 v7, s[52:55], s21 offen offset:1024 lds
    s_add_u32 s21, s21, 65536
    v_mfma_f32_32x32x16_bf16 a[160:175], v[52:55], a[64:67], a[160:175]
    s_add_u32 m0, s24, 6144
    s_nop 0
    buffer_load_dwordx4 v6, s[52:55], s21 offen lds
    v_mfma_f32_32x32x16_bf16 a[176:191], v[52:55], a[68:71], a[176:191]
    s_waitcnt vmcnt(19)
    ds_read_b128 v[48:51], v22 offset:8192
    ds_read_b128 v[52:55], v22 offset:12288
    s_waitcnt lgkmcnt(2)
    v_mfma_f32_32x32x16_bf16 a[128:143], v[56:59], a[72:75], a[128:143]
    buffer_load_dwordx4 v7, s[52:55], s21 offen offset:1024 lds
    s_add_u32 s21, s21, 65536
    v_mfma_f32_32x32x16_bf16 a[144:159], v[56:59], a[76:79], a[144:159]
    s_add_u32 m0, s25, 0
    s_nop 0
    buffer_load_dwordx4 v6, s[52:55], s21 offen lds
    v_mfma_f32_32x32x16_bf16 a[160:175], v[60:63], a[72:75], a[160:175]
    buffer_load_dwordx4 v7, s[52:55], s21 offen offset:1024 lds
    s_add_u32 s21, s21, 65536
    v_mfma_f32_32x32x16_bf16 a[176:191], v[60:63], a[76:79], a[176:191]
    s_waitcnt vmcnt(20)
    ds_read_b128 v[56:59], v23 offset:8192
    ds_read_b128 v[60:63], v23 offset:12288
    s_waitcnt lgkmcnt(2)
    v_mfma_f32_32x32x16_bf16 a[128:143], v[48:51], a[80:83], a[128:143]
    s_add_u32 m0, s25, 2048
    s_nop 0
    buffer_load_dwordx4 v6, s[52:55], s21 offen lds
    v_mfma_f32_32x32x16_bf16 a[144:159], v[48:51], a[84:87], a[144:159]
    buffer_load_dwordx4 v7, s[52:55], s21 offen offset:1024 lds
    s_add_u32 s21, s21, 65536
    v_mfma_f32_32x32x16_bf16 a[160:175], v[52:55], a[80:83], a[160:175]
    s_add_u32 m0, s25, 4096
    s_nop 0
    buffer_load_dwordx4 v6, s[52:55], s21 offen lds
    v_mfma_f32_32x32x16_bf16 a[176:191], v[52:55], a[84:87], a[176:191]
    s_waitcnt vmcnt(21)
    ds_read_b128 v[48:51], v20 offset:16384
    ds_read_b128 v[52:55], v20 offset:20480
    s_waitcnt lgkmcnt(2)
    v_mfma_f32_32x32x16_bf16 a[128:143], v[56:59], a[88:91], a[128:143]
    buffer_load_dwordx4 v7, s[52:55], s21 offen offset:1024 lds
    s_add_u32 s21, s21, 65536
    v_mfma_f32_32x32x16_bf16 a[144:159], v[56:59], a[92:95], a[144:159]
    s_add_u32 m0, s25, 6144
    s_nop 0
    buffer_load_dwordx4 v6, s[52:55], s21 offen lds
    v_mfma_f32_32x32x16_bf16 a[160:175], v[60:63], a[88:91], a[160:175]
    buffer_load_dwordx4 v7, s[52:55], s21 offen offset:1024 lds
    s_add_u32 s21, s21, 65536
    v_mfma_f32_32x32x16_bf16 a[176:191], v[60:63], a[92:95], a[176:191]
    s_waitcnt vmcnt(22)
    ds_read_b128 v[56:59], v21 offset:16384
    ds_read_b128 v[60:63], v21 offset:20480
    s_waitcnt lgkmcnt(2)
    v_mfma_f32_32x32x16_bf16 a[128:143], v[48:51], a[96:99], a[128:143]
    v_mfma_f32_32x32x16_bf16 a[144:159], v[48:51], a[100:103], a[144:159]
    v_mfma_f32_32x32x16_bf16 a[160:175], v[52:55], a[96:99], a[160:175]
    v_mfma_f32_32x32x16_bf16 a[176:191], v[52:55], a[100:103], a[176:191]
    s_waitcnt vmcnt(20)
    ds_read_b128 v[48:51], v22 offset:16384
    ds_read_b128 v[52:55], v22 offset:20480
    s_waitcnt lgkmcnt(2)
    buffer_load_dword v238, v19, s[64:67], s13 offen sc1
    v_mfma_f32_32x32x16_bf16 a[128:143], v[56:59], a[104:107], a[128:143]
    v_mfma_f32_32x32x16_bf16 a[144:159], v[56:59], a[108:111], a[144:159]
    v_mfma_f32_32x32x16_bf16 a[160:175], v[60:63], a[104:107], a[160:175]
    v_mfma_f32_32x32x16_bf16 a[176:191], v[60:63], a[108:111], a[176:191]
    s_waitcnt vmcnt(19)
    ds_read_b128 v[56:59], v23 offset:16384
    ds_read_b128 v[60:63], v23 offset:20480
    s_waitcnt lgkmcnt(2)
    v_mfma_f32_32x32x16_bf16 a[128:143], v[48:51], a[112:115], a[128:143]
    v_mfma_f32_32x32x16_bf16 a[144:159], v[48:51], a[116:119], a[144:159]
    v_mfma_f32_32x32x16_bf16 a[160:175], v[52:55], a[112:115], a[160:175]
    v_mfma_f32_32x32x16_bf16 a[176:191], v[52:55], a[116:119], a[176:191]
    s_waitcnt vmcnt(17) lgkmcnt(0)
    v_mfma_f32_32x32x16_bf16 a[128:143], v[56:59], a[120:123], a[128:143]
    v_mfma_f32_32x32x16_bf16 a[144:159], v[56:59], a[124:127], a[144:159]
    v_mfma_f32_32x32x16_bf16 a[160:175], v[60:63], a[120:123], a[160:175]
    v_mfma_f32_32x32x16_bf16 a[176:191], v[60:63], a[124:127], a[176:191]
    s_waitcnt vmcnt(0)
    v_cmp_ne_u32 s[10:11], v238, v236
    s_nop 1
    s_cmp_eq_u64 s[10:11], 0
    s_cselect_b32 s50, 1409024, 0
    s_nop 2
    ds_write_b128 v36, a[128:131] offset:8192
    ds_write_b128 v37, a[132:135] offset:9216
    ds_write_b128 v38, a[136:139] offset:10240
    ds_write_b128 v39, a[140:143] offset:11264
    ds_write_b128 v36, a[144:147] offset:12288
    buffer_load_dwordx4 a[0:3], v13, s[48:51], s20 offen offset:0 sc1
    ds_write_b128 v37, a[148:151] offset:13312
    ds_write_b128 v38, a[152:155] offset:14336
    ds_write_b128 v39, a[156:159] offset:15360
    ds_write_b128 v40, a[160:163] offset:16384
    ds_write_b128 v41, a[164:167] offset:17408
    buffer_load_dwordx4 a[4:7], v13, s[48:51], s20 offen offset:512 sc1
    s_add_u32 s20, s20, 16384
    ds_write_b128 v42, a[168:171] offset:18432
    ds_write_b128 v43, a[172:175] offset:19456
    ds_write_b128 v40, a[176:179] offset:20480
    ds_write_b128 v41, a[180:183] offset:21504
    ds_write_b128 v42, a[184:187] offset:22528
    buffer_load_dwordx4 a[8:11], v13, s[48:51], s20 offen offset:0 sc1
    ds_write_b128 v43, a[188:191] offset:23552
    s_waitcnt lgkmcnt(0)
    s_barrier
    ds_read_b128 v[72:75], v64 offset:0
    ds_read_b128 v[76:79], v65 offset:0
    buffer_load_dwordx4 a[12:15], v13, s[48:51], s20 offen offset:512 sc1
    s_add_u32 s20, s20, 16384
    ds_read_b128 v[80:83], v66 offset:0
    ds_read_b128 v[84:87], v67 offset:0
    ds_read_b128 v[104:107], v64 offset:24576
    ds_read_b128 v[108:111], v65 offset:24576
    ds_read_b128 v[112:115], v66 offset:24576
    buffer_load_dwordx4 a[16:19], v13, s[48:51], s20 offen offset:0 sc1
    ds_read_b128 v[116:119], v67 offset:24576
    ds_read_b128 v[120:123], v68 offset:0
    ds_read_b128 v[124:127], v69 offset:0
    ds_read_b128 v[128:131], v70 offset:0
    ds_read_b128 v[132:135], v71 offset:0
    buffer_load_dwordx4 a[20:23], v13, s[48:51], s20 offen offset:512 sc1
    s_add_u32 s20, s20, 16384
    ds_read_b128 v[136:139], v68 offset:24576
    ds_read_b128 v[140:143], v69 offset:24576
    ds_read_b128 v[144:147], v70 offset:24576
    ds_read_b128 v[148:151], v71 offset:24576
    s_waitcnt lgkmcnt(0)
    s_barrier
    buffer_load_dwordx4 a[24:27], v13, s[48:51], s20 offen offset:0 sc1
    v_pk_add_f32 v[72:73], v[72:73], v[104:105]
    v_pk_add_f32 v[74:75], v[74:75], v[106:107]
    v_pk_add_f32 v[76:77], v[76:77], v[108:109]
    v_pk_add_f32 v[78:79], v[78:79], v[110:111]
    v_pk_add_f32 v[80:81], v[80:81], v[112:113]
    buffer_load_dwordx4 a[28:31], v13, s[48:51], s20 offen offset:512 sc1
    s_add_u32 s20, s20, 16384
    v_pk_add_f32 v[82:83], v[82:83], v[114:115]
    v_pk_add_f32 v[84:85], v[84:85], v[116:117]
    v_pk_add_f32 v[86:87], v[86:87], v[118:119]
    v_pk_add_f32 v[120:121], v[120:121], v[136:137]
    v_pk_add_f32 v[122:123], v[122:123], v[138:139]
    buffer_load_dwordx4 a[32:35], v13, s[48:51], s20 offen offset:0 sc1
    v_pk_add_f32 v[124:125], v[124:125], v[140:141]
    v_pk_add_f32 v[126:127], v[126:127], v[142:143]
    v_pk_add_f32 v[128:129], v[128:129], v[144:145]
    v_pk_add_f32 v[130:131], v[130:131], v[146:147]
    v_pk_add_f32 v[132:133], v[132:133], v[148:149]
    buffer_load_dwordx4 a[36:39], v13, s[48:51], s20 offen offset:512 sc1
    s_add_u32 s20, s20, 16384
    v_pk_add_f32 v[134:135], v[134:135], v[150:151]
    v_pk_add_f32 v[72:73], v[72:73], v[120:121]
    v_pk_add_f32 v[74:75], v[74:75], v[122:123]
    v_pk_add_f32 v[76:77], v[76:77], v[124:125]
    v_pk_add_f32 v[78:79], v[78:79], v[126:127]
    buffer_load_dwordx4 a[40:43], v13, s[48:51], s20 offen offset:0 sc1
    v_pk_add_f32 v[80:81], v[80:81], v[128:129]
    v_pk_add_f32 v[82:83], v[82:83], v[130:131]
    v_pk_add_f32 v[84:85], v[84:85], v[132:133]
    v_pk_add_f32 v[86:87], v[86:87], v[134:135]
    v_lshlrev_b32 v104, 16, v224
    buffer_load_dwordx4 a[44:47], v13, s[48:51], s20 offen offset:512 sc1
    s_add_u32 s20, s20, 16384
    v_and_b32 v105, 0xffff0000, v224
    v_pk_add_f32 v[72:73], v[72:73], v[104:105]
    v_lshlrev_b32 v106, 16, v225
    v_and_b32 v107, 0xffff0000, v225
    v_pk_add_f32 v[74:75], v[74:75], v[106:107]
    buffer_load_dwordx4 a[48:51], v13, s[48:51], s20 offen offset:0 sc1
    v_lshlrev_b32 v104, 16, v226
    v_and_b32 v105, 0xffff0000, v226
    v_pk_add_f32 v[76:77], v[76:77], v[104:105]
    v_lshlrev_b32 v106, 16, v227
    v_and_b32 v107, 0xffff0000, v227
    buffer_load_dwordx4 a[52:55], v13, s[48:51], s20 offen offset:512 sc1
    s_add_u32 s20, s20, 16384
    v_pk_add_f32 v[78:79], v[78:79], v[106:107]
    v_lshlrev_b32 v104, 16, v228
    v_and_b32 v105, 0xffff0000, v228
    v_pk_add_f32 v[80:81], v[80:81], v[104:105]
    v_lshlrev_b32 v106, 16, v229
    buffer_load_dwordx4 a[56:59], v13, s[48:51], s20 offen offset:0 sc1
    v_and_b32 v107, 0xffff0000, v229
    v_pk_add_f32 v[82:83], v[82:83], v[106:107]
    v_lshlrev_b32 v104, 16, v230
    v_and_b32 v105, 0xffff0000, v230
    v_pk_add_f32 v[84:85], v[84:85], v[104:105]
    buffer_load_dwordx4 a[60:63], v13, s[48:51], s20 offen offset:512 sc1
    s_add_u32 s20, s20, 16384
    v_lshlrev_b32 v106, 16, v231
    v_and_b32 v107, 0xffff0000, v231
    v_pk_add_f32 v[86:87], v[86:87], v[106:107]
    ds_read_b64_tr_b16 v[48:49], v10 offset:8192
    ds_read_b64_tr_b16 v[50:51], v10 offset:8704
    ds_read_b64_tr_b16 v[52:53], v11 offset:8192
    ds_read_b64_tr_b16 v[54:55], v11 offset:8704
    s_cmp_eq_u64 s[10:11], 0
    s_cbranch_scc1 kud
    v_cmp_ne_u32 s[6:7], v238, v236
    s_nop 1
    s_cmp_eq_u64 s[6:7], 0
    s_cbranch_scc1 kp3_ok
    s_mov_b32 s3, 0
kp3_lp:
    s_sleep 1
    buffer_load_dword v238, v19, s[64:67], s13 offen sc1
    s_waitcnt vmcnt(0)
    v_cmp_ne_u32 s[6:7], v238, v236
    s_add_u32 s3, s3, 1
    s_nop 0
    s_cmp_eq_u64 s[6:7], 0
    s_cbranch_scc1 kp3_ok
    s_cmp_lt_u32 s3, 200000
    s_cbranch_scc1 kp3_lp
kp3_ok:
    s_mov_b32 s50, 1409024
    s_sub_u32 s20, s20, 131072
    buffer_load_dwordx4 a[0:3], v13, s[48:51], s20 offen offset:0 sc1
    buffer_load_dwordx4 a[4:7], v13, s[48:51], s20 offen offset:512 sc1
    s_add_u32 s20, s20, 16384
    buffer_load_dwordx4 a[8:11], v13, s[48:51], s20 offen offset:0 sc1
    buffer_load_dwordx4 a[12:15], v13, s[48:51], s20 offen offset:512 sc1
    s_add_u32 s20, s20, 16384
    buffer_load_dwordx4 a[16:19], v13, s[48:51], s20 offen offset:0 sc1
    buffer_load_dwordx4 a[20:23], v13, s[48:51], s20 offen offset:512 sc1
    s_add_u32 s20, s20, 16384
    buffer_load_dwordx4 a[24:27], v13, s[48:51], s20 offen offset:0 sc1
    buffer_load_dwordx4 a[28:31], v13, s[48:51], s20 offen offset:512 sc1
    s_add_u32 s20, s20, 16384
    buffer_load_dwordx4 a[32:35], v13, s[48:51], s20 offen offset:0 sc1
    buffer_load_dwordx4 a[36:39], v13, s[48:51], s20 offen offset:512 sc1
    s_add_u32 s20, s20, 16384
    buffer_load_dwordx4 a[40:43], v13, s[48:51], s20 offen offset:0 sc1
    buffer_load_dwordx4 a[44:47], v13, s[48:51], s20 offen offset:512 sc1
    s_add_u32 s20, s20, 16384
    buffer_load_dwordx4 a[48:51], v13, s[48:51], s20 offen offset:0 sc1
    buffer_load_dwordx4 a[52:55], v13, s[48:51], s20 offen offset:512 sc1
    s_add_u32 s20, s20, 16384
    buffer_load_dwordx4 a[56:59], v13, s[48:51], s20 offen offset:0 sc1
    buffer_load_dwordx4 a[60:63], v13, s[48:51], s20 offen offset:512 sc1
    s_add_u32 s20, s20, 16384
kud:
    s_waitcnt vmcnt(14)
    ds_read_b64_tr_b16 v[56:57], v10 offset:10240
    ds_read_b64_tr_b16 v[58:59], v10 offset:10752
    ds_read_b64_tr_b16 v[60:61], v11 offset:10240
    ds_read_b64_tr_b16 v[62:63], v11 offset:10752
    s_waitcnt lgkmcnt(4)
    v_mfma_f32_32x32x16_bf16 a[192:207], a[0:3], v[48:51], 0
    buffer_load_dwordx4 a[64:67], v13, s[48:51], s20 offen offset:0 sc1
    v_mfma_f32_32x32x16_bf16 a[224:239], a[4:7], v[48:51], 0
    buffer_load_dwordx4 a[68:71], v13, s[48:51], s20 offen offset:512 sc1
    s_add_u32 s20, s20, 16384
    v_mfma_f32_32x32x16_bf16 a[208:223], a[0:3], v[52:55], 0
    buffer_load_dwordx4 a[72:75], v13, s[48:51], s20 offen offset:0 sc1
    v_mfma_f32_32x32x16_bf16 a[240:255], a[4:7], v[52:55], 0
    v_lshlrev_b32 v160, 16, v216
    v_and_b32 v161, 0xffff0000, v216
    s_waitcnt vmcnt(15)
    ds_read_b64_tr_b16 v[48:49], v10 offset:12288
    ds_read_b64_tr_b16 v[50:51], v10 offset:12800
    ds_read_b64_tr_b16 v[52:53], v11 offset:12288
    ds_read_b64_tr_b16 v[54:55], v11 offset:12800
    s_waitcnt lgkmcnt(4)
    v_mfma_f32_32x32x16_bf16 a[192:207], a[8:11], v[56:59], a[192:207]
    buffer_load_dwordx4 a[76:79], v13, s[48:51], s20 offen offset:512 sc1
    s_add_u32 s20, s20, 16384
    v_mfma_f32_32x32x16_bf16 a[224:239], a[12:15], v[56:59], a[224:239]
    buffer_load_dwordx4 a[80:83], v13, s[48:51], s20 offen offset:0 sc1
    v_mfma_f32_32x32x16_bf16 a[208:223], a[8:11], v[60:63], a[208:223]
    buffer_load_dwordx4 a[84:87], v13, s[48:51], s20 offen offset:512 sc1
    s_add_u32 s20, s20, 16384
    v_mfma_f32_32x32x16_bf16 a[240:255], a[12:15], v[60:63], a[240:255]
    v_lshlrev_b32 v162, 16, v217
    v_and_b32 v163, 0xffff0000, v217
    s_waitcnt vmcnt(16)
    ds_read_b64_tr_b16 v[56:57], v10 offset:14336
    ds_read_b64_tr_b16 v[58:59], v10 offset:14848
    ds_read_b64_tr_b16 v[60:61], v11 offset:14336
    ds_read_b64_tr_b16 v[62:63], v11 offset:14848
    s_waitcnt lgkmcnt(4)
    v_mfma_f32_32x32x16_bf16 a[192:207], a[16:19], v[48:51], a[192:207]
    buffer_load_dwordx4 a[88:91], v13, s[48:51], s20 offen offset:0 sc1
    v_mfma_f32_32x32x16_bf16 a[224:239], a[20:23], v[48:51], a[224:239]
    buffer_load_dwordx4 a[92:95], v13, s[48:51], s20 offen offset:512 sc1
    s_add_u32 s20, s20, 16384
    v_mfma_f32_32x32x16_bf16 a[208:223], a[16:19], v[52:55], a[208:223]
    s_add_u32 m0, s24, 8192
    s_nop 0
    buffer_load_dwordx4 v6, s[52:55], s21 offen lds
    v_mfma_f32_32x32x16_bf16 a[240:255], a[20:23], v[52:55], a[240:255]
    v_lshlrev_b32 v164, 16, v218
    v_and_b32 v165, 0xffff0000, v218
    s_waitcnt vmcnt(17)
    ds_read_b64_tr_b16 v[48:49], v8 offset:0
    ds_read_b64_tr_b16 v[50:51], v8 offset:512
    ds_read_b64_tr_b16 v[52:53], v9 offset:0
    ds_read_b64_tr_b16 v[54:55], v9 offset:512
    s_waitcnt lgkmcnt(4)
    v_mfma_f32_32x32x16_bf16 a[192:207], a[24:27], v[56:59], a[192:207]
    buffer_load_dwordx4 v7, s[52:55], s21 offen offset:1024 lds
    s_add_u32 s21, s21, 65536
    v_mfma_f32_32x32x16_bf16 a[224:239], a[28:31], v[56:59], a[224:239]
    buffer_load_dwordx4 a[96:99], v13, s[48:51], s20 offen offset:0 sc1
    v_mfma_f32_32x32x16_bf16 a[208:223], a[24:27], v[60:63], a[208:223]
    buffer_load_dwordx4 a[100:103], v13, s[48:51], s20 offen offset:512 sc1
    s_add_u32 s20, s20, 16384
    v_mfma_f32_32x32x16_bf16 a[240:255], a[28:31], v[60:63], a[240:255]
    v_lshlrev_b32 v166, 16, v219
    v_and_b32 v167, 0xffff0000, v219
    s_waitcnt vmcnt(18)
    ds_read_b64_tr_b16 v[56:57], v8 offset:2048
    ds_read_b64_tr_b16 v[58:59], v8 offset:2560
    ds_read_b64_tr_b16 v[60:61], v9 offset:2048
    ds_read_b64_tr_b16 v[62:63], v9 offset:2560
    s_waitcnt lgkmcnt(4)
    v_mfma_f32_32x32x16_bf16 a[192:207], a[32:35], v[48:51], a[192:207]
    s_add_u32 m0, s24, 10240
    s_nop 0
    buffer_load_dwordx4 v6, s[52:55], s21 offen lds
    v_mfma_f32_32x32x16_bf16 a[224:239], a[36:39], v[48:51], a[224:239]
    buffer_load_dwordx4 v7, s[52:55], s21 offen offset:1024 lds
    s_add_u32 s21, s21, 65536
    v_mfma_f32_32x32x16_bf16 a[208:223], a[32:35], v[52:55], a[208:223]
    buffer_load_dwordx4 a[104:107], v13, s[48:51], s20 offen offset:0 sc1
    v_mfma_f32_32x32x16_bf16 a[240:255], a[36:39], v[52:55], a[240:255]
    v_lshlrev_b32 v168, 16, v220
    v_and_b32 v169, 0xffff0000, v220
    s_waitcnt vmcnt(19)
    ds_read_b64_tr_b16 v[48:49], v8 offset:4096
    ds_read_b64_tr_b16 v[50:51], v8 offset:4608
    ds_read_b64_tr_b16 v[52:53], v9 offset:4096
    ds_read_b64_tr_b16 v[54:55], v9 offset:4608
    s_waitcnt lgkmcnt(4)
    v_mfma_f32_32x32x16_bf16 a[192:207], a[40:43], v[56:59], a[192:207]
    buffer_load_dwordx4 a[108:111], v13, s[48:51], s20 offen offset:512 sc1
    s_add_u32 s20, s20, 16384
    v_mfma_f32_32x32x16_bf16 a[224:239], a[44:47], v[56:59], a[224:239]
    s_add_u32 m0, s24, 12288
    s_nop 0
    buffer_load_dwordx4 v6, s[52:55], s21 offen lds
    v_mfma_f32_32x32x16_bf16 a[208:223], a[40:43], v[60:63], a[208:223]
    buffer_load_dwordx4 v7, s[52:55], s21 offen offset:1024 lds
    s_add_u32 s21, s21, 65536
    v_mfma_f32_32x32x16_bf16 a[240:255], a[44:47], v[60:63], a[240:255]
    v_lshlrev_b32 v170, 16, v221
    v_and_b32 v171, 0xffff0000, v221
    s_waitcnt vmcnt(20)
    ds_read_b64_tr_b16 v[56:57], v8 offset:6144
    ds_read_b64_tr_b16 v[58:59], v8 offset:6656
    ds_read_b64_tr_b16 v[60:61], v9 offset:6144
    ds_read_b64_tr_b16 v[62:63], v9 offset:6656
    s_waitcnt lgkmcnt(4)
    v_mfma_f32_32x32x16_bf16 a[192:207], a[48:51], v[48:51], a[192:207]
    buffer_load_dwordx4 a[112:115], v13, s[48:51], s20 offen offset:0 sc1
    v_mfma_f32_32x32x16_bf16 a[224:239], a[52:55], v[48:51], a[224:239]
    buffer_load_dwordx4 a[116:119], v13, s[48:51], s20 offen offset:512 sc1
    s_add_u32 s20, s20, 16384
    v_mfma_f32_32x32x16_bf16 a[208:223], a[48:51], v[52:55], a[208:223]
    s_add_u32 m0, s24, 14336
    s_nop 0
    buffer_load_dwordx4 v6, s[52:55], s21 offen lds
    v_mfma_f32_32x32x16_bf16 a[240:255], a[52:55], v[52:55], a[240:255]
    v_lshlrev_b32 v172, 16, v222
    v_and_b32 v173, 0xffff0000, v222
    s_waitcnt vmcnt(21)
    ds_read_b64_tr_b16 v[48:49], v10 offset:0
    ds_read_b64_tr_b16 v[50:51], v10 offset:512
    ds_read_b64_tr_b16 v[52:53], v11 offset:0
    ds_read_b64_tr_b16 v[54:55], v11 offset:512
    s_waitcnt lgkmcnt(4)
    v_mfma_f32_32x32x16_bf16 a[192:207], a[56:59], v[56:59], a[192:207]
    buffer_load_dwordx4 v7, s[52:55], s21 offen offset:1024 lds
    s_add_u32 s21, s21, 65536
    v_mfma_f32_32x32x16_bf16 a[224:239], a[60:63], v[56:59], a[224:239]
    buffer_load_dwordx4 a[120:123], v13, s[48:51], s20 offen offset:0 sc1
    v_mfma_f32_32x32x16_bf16 a[208:223], a[56:59], v[60:63], a[208:223]
    buffer_load_dwordx4 a[124:127], v13, s[48:51], s20 offen offset:512 sc1
    s_add_u32 s20, s20, 16384
    v_mfma_f32_32x32x16_bf16 a[240:255], a[60:63], v[60:63], a[240:255]
    v_lshlrev_b32 v174, 16, v223
    v_and_b32 v175, 0xffff0000, v223
    s_waitcnt vmcnt(22)
    ds_read_b64_tr_b16 v[56:57], v10 offset:2048
    ds_read_b64_tr_b16 v[58:59], v10 offset:2560
    ds_read_b64_tr_b16 v[60:61], v11 offset:2048
    ds_read_b64_tr_b16 v[62:63], v11 offset:2560
    s_waitcnt lgkmcnt(4)
    v_mfma_f32_32x32x16_bf16 a[192:207], a[64:67], v[48:51], a[192:207]
    s_add_u32 m0, s24, 16384
    s_nop 0
    buffer_load_dwordx4 v6, s[52:55], s21 offen lds
    v_mfma_f32_32x32x16_bf16 a[224:239], a[68:71], v[48:51], a[224:239]
    buffer_load_dwordx4 v7, s[52:55], s21 offen offset:1024 lds
    s_add_u32 s21, s21, 65536
    v_mfma_f32_32x32x16_bf16 a[208:223], a[64:67], v[52:55], a[208:223]
    buffer_load_dwordx4 a[128:131], v13, s[48:51], s20 offen offset:0 sc1
    v_mfma_f32_32x32x16_bf16 a[240:255], a[68:71], v[52:55], a[240:255]
    s_mov_b32 s56, s32
    s_and_b32 s57, s33, 0xffff
    s_mov_b32 s58, 4194304
    s_mov_b32 s59, 0x20000
    s_waitcnt vmcnt(23)
    ds_read_b64_tr_b16 v[48:49], v10 offset:4096
    ds_read_b64_tr_b16 v[50:51], v10 offset:4608
    ds_read_b64_tr_b16 v[52:53], v11 offset:4096
    ds_read_b64_tr_b16 v[54:55], v11 offset:4608
    s_waitcnt lgkmcnt(4)
    v_mfma_f32_32x32x16_bf16 a[192:207], a[72:75], v[56:59], a[192:207]
    buffer_load_dwordx4 a[132:135], v13, s[48:51], s20 offen offset:512 sc1
    s_add_u32 s20, s20, 16384
    v_mfma_f32_32x32x16_bf16 a[224:239], a[76:79], v[56:59], a[224:239]
    s_add_u32 m0, s24, 18432
    s_nop 0
    buffer_load_dwordx4 v6, s[52:55], s21 offen lds
    v_mfma_f32_32x32x16_bf16 a[208:223], a[72:75], v[60:63], a[208:223]
    buffer_load_dwordx4 v7, s[52:55], s21 offen offset:1024 lds
    s_add_u32 s21, s21, 65536
    v_mfma_f32_32x32x16_bf16 a[240:255], a[76:79], v[60:63], a[240:255]
    v_lshlrev_b32 v24, 11, v3
    v_lshl_add_u32 v24, v2, 4, v24
    s_waitcnt vmcnt(24)
    ds_read_b64_tr_b16 v[56:57], v10 offset:6144
    ds_read_b64_tr_b16 v[58:59], v10 offset:6656
    ds_read_b64_tr_b16 v[60:61], v11 offset:6144
    ds_read_b64_tr_b16 v[62:63], v11 offset:6656
    s_waitcnt lgkmcnt(4)
    v_mfma_f32_32x32x16_bf16 a[192:207], a[80:83], v[48:51], a[192:207]
    buffer_load_dwordx4 a[136:139], v13, s[48:51], s20 offen offset:0 sc1
    v_mfma_f32_32x32x16_bf16 a[224:239], a[84:87], v[48:51], a[224:239]
    buffer_load_dwordx4 a[140:143], v13, s[48:51], s20 offen offset:512 sc1
    s_add_u32 s20, s20, 16384
    v_mfma_f32_32x32x16_bf16 a[208:223], a[80:83], v[52:55], a[208:223]
    s_add_u32 m0, s24, 20480
    s_nop 0
    buffer_load_dwordx4 v6, s[52:55], s21 offen lds
    v_mfma_f32_32x32x16_bf16 a[240:255], a[84:87], v[52:55], a[240:255]
    s_lshl_b32 s77, s73, 17
    s_lshl_b32 s78, s72, 15
    s_add_u32 s77, s77, s78
    s_lshl_b32 s78, s74, 8
    s_add_u32 s19, s77, s78
    s_waitcnt vmcnt(23)
    ds_read_b64_tr_b16 v[48:49], v8 offset:8192
    ds_read_b64_tr_b16 v[50:51], v8 offset:8704
    ds_read_b64_tr_b16 v[52:53], v9 offset:8192
    ds_read_b64_tr_b16 v[54:55], v9 offset:8704
    s_waitcnt lgkmcnt(4)
    v_mfma_f32_32x32x16_bf16 a[192:207], a[88:91], v[56:59], a[192:207]
    buffer_load_dwordx4 v7, s[52:55], s21 offen offset:1024 lds
    s_add_u32 s21, s21, 65536
    v_mfma_f32_32x32x16_bf16 a[224:239], a[92:95], v[56:59], a[224:239]
    buffer_load_dwordx4 a[144:147], v13, s[48:51], s20 offen offset:0 sc1
    v_mfma_f32_32x32x16_bf16 a[208:223], a[88:91], v[60:63], a[208:223]
    buffer_load_dwordx4 a[148:151], v13, s[48:51], s20 offen offset:512 sc1
    s_add_u32 s20, s20, 16384
    v_mfma_f32_32x32x16_bf16 a[240:255], a[92:95], v[60:63], a[240:255]
    s_waitcnt vmcnt(22)
    ds_read_b64_tr_b16 v[56:57], v8 offset:10240
    ds_read_b64_tr_b16 v[58:59], v8 offset:10752
    ds_read_b64_tr_b16 v[60:61], v9 offset:10240
    ds_read_b64_tr_b16 v[62:63], v9 offset:10752
    s_waitcnt lgkmcnt(4)
    v_mfma_f32_32x32x16_bf16 a[192:207], a[96:99], v[48:51], a[192:207]
    s_add_u32 m0, s24, 22528
    s_nop 0
    buffer_load_dwordx4 v6, s[52:55], s21 offen lds
    v_mfma_f32_32x32x16_bf16 a[224:239], a[100:103], v[48:51], a[224:239]
    buffer_load_dwordx4 v7, s[52:55], s21 offen offset:1024 lds
    s_add_u32 s21, s21, 65536
    v_mfma_f32_32x32x16_bf16 a[208:223], a[96:99], v[52:55], a[208:223]
    buffer_load_dwordx4 a[152:155], v13, s[48:51], s20 offen offset:0 sc1
    v_mfma_f32_32x32x16_bf16 a[240:255], a[100:103], v[52:55], a[240:255]
    s_waitcnt vmcnt(21)
    ds_read_b64_tr_b16 v[48:49], v8 offset:12288
    ds_read_b64_tr_b16 v[50:51], v8 offset:12800
    ds_read_b64_tr_b16 v[52:53], v9 offset:12288
    ds_read_b64_tr_b16 v[54:55], v9 offset:12800
    s_waitcnt lgkmcnt(4)
    v_mfma_f32_32x32x16_bf16 a[192:207], a[104:107], v[56:59], a[192:207]
    buffer_load_dwordx4 a[156:159], v13, s[48:51], s20 offen offset:512 sc1
    s_add_u32 s20, s20, 16384
    v_mfma_f32_32x32x16_bf16 a[224:239], a[108:111], v[56:59], a[224:239]
    s_add_u32 m0, s25, 8192
    s_nop 0
    buffer_load_dwordx4 v6, s[52:55], s21 offen lds
    v_mfma_f32_32x32x16_bf16 a[208:223], a[104:107], v[60:63], a[208:223]
    buffer_load_dwordx4 v7, s[52:55], s21 offen offset:1024 lds
    s_add_u32 s21, s21, 65536
    v_mfma_f32_32x32x16_bf16 a[240:255], a[108:111], v[60:63], a[240:255]
    s_waitcnt vmcnt(20)
    ds_read_b64_tr_b16 v[56:57], v8 offset:14336
    ds_read_b64_tr_b16 v[58:59], v8 offset:14848
    ds_read_b64_tr_b16 v[60:61], v9 offset:14336
    ds_read_b64_tr_b16 v[62:63], v9 offset:14848
    s_waitcnt lgkmcnt(4)
    v_mfma_f32_32x32x16_bf16 a[192:207], a[112:115], v[48:51], a[192:207]
    buffer_load_dwordx4 a[160:163], v13, s[48:51], s20 offen offset:0 sc1
    v_mfma_f32_32x32x16_bf16 a[224:239], a[116:119], v[48:51], a[224:239]
    buffer_load_dwordx4 a[164:167], v13, s[48:51], s20 offen offset:512 sc1
    s_add_u32 s20, s20, 16384
    v_mfma_f32_32x32x16_bf16 a[208:223], a[112:115], v[52:55], a[208:223]
    s_add_u32 m0, s25, 10240
    s_nop 0
    buffer_load_dwordx4 v6, s[52:55], s21 offen lds
    v_mfma_f32_32x32x16_bf16 a[240:255], a[116:119], v[52:55], a[240:255]
    s_waitcnt vmcnt(19)
    ds_read_b64_tr_b16 v[48:49], v8 offset:16384
    ds_read_b64_tr_b16 v[50:51], v8 offset:16896
    ds_read_b64_tr_b16 v[52:53], v9 offset:16384
    ds_read_b64_tr_b16 v[54:55], v9 offset:16896
    s_waitcnt lgkmcnt(4)
    v_mfma_f32_32x32x16_bf16 a[192:207], a[120:123], v[56:59], a[192:207]
    buffer_load_dwordx4 v7, s[52:55], s21 offen offset:1024 lds
    s_add_u32 s21, s21, 65536
    v_mfma_f32_32x32x16_bf16 a[224:239], a[124:127], v[56:59], a[224:239]
    buffer_load_dwordx4 a[168:171], v13, s[48:51], s20 offen offset:0 sc1
    v_mfma_f32_32x32x16_bf16 a[208:223], a[120:123], v[60:63], a[208:223]
    buffer_load_dwordx4 a[172:175], v13, s[48:51], s20 offen offset:512 sc1
    s_add_u32 s20, s20, 16384
    v_mfma_f32_32x32x16_bf16 a[240:255], a[124:127], v[60:63], a[240:255]
    s_waitcnt vmcnt(18)
    ds_read_b64_tr_b16 v[56:57], v8 offset:18432
    ds_read_b64_tr_b16 v[58:59], v8 offset:18944
    ds_read_b64_tr_b16 v[60:61], v9 offset:18432
    ds_read_b64_tr_b16 v[62:63], v9 offset:18944
    s_waitcnt lgkmcnt(4)
    v_mfma_f32_32x32x16_bf16 a[192:207], a[128:131], v[48:51], a[192:207]
    v_mfma_f32_32x32x16_bf16 a[224:239], a[132:135], v[48:51], a[224:239]
    v_mfma_f32_32x32x16_bf16 a[208:223], a[128:131], v[52:55], a[208:223]
    v_mfma_f32_32x32x16_bf16 a[240:255], a[132:135], v[52:55], a[240:255]
    s_waitcnt vmcnt(14)
    ds_read_b64_tr_b16 v[48:49], v8 offset:20480
    ds_read_b64_tr_b16 v[50:51], v8 offset:20992
    ds_read_b64_tr_b16 v[52:53], v9 offset:20480
    ds_read_b64_tr_b16 v[54:55], v9 offset:20992
    s_waitcnt lgkmcnt(4)
    v_mfma_f32_32x32x16_bf16 a[192:207], a[136:139], v[56:59], a[192:207]
    v_mfma_f32_32x32x16_bf16 a[224:239], a[140:143], v[56:59], a[224:239]
    v_mfma_f32_32x32x16_bf16 a[208:223], a[136:139], v[60:63], a[208:223]
    v_mfma_f32_32x32x16_bf16 a[240:255], a[140:143], v[60:63], a[240:255]
    s_waitcnt vmcnt(10)
    ds_read_b64_tr_b16 v[56:57], v8 offset:22528
    ds_read_b64_tr_b16 v[58:59], v8 offset:23040
    ds_read_b64_tr_b16 v[60:61], v9 offset:22528
    ds_read_b64_tr_b16 v[62:63], v9 offset:23040
    s_waitcnt lgkmcnt(4)
    v_mfma_f32_32x32x16_bf16 a[192:207], a[144:147], v[48:51], a[192:207]
    v_mfma_f32_32x32x16_bf16 a[224:239], a[148:151], v[48:51], a[224:239]
    v_mfma_f32_32x32x16_bf16 a[208:223], a[144:147], v[52:55], a[208:223]
    v_mfma_f32_32x32x16_bf16 a[240:255], a[148:151], v[52:55], a[240:255]
    s_waitcnt vmcnt(6)
    ds_read_b64_tr_b16 v[48:49], v10 offset:8192
    ds_read_b64_tr_b16 v[50:51], v10 offset:8704
    ds_read_b64_tr_b16 v[52:53], v11 offset:8192
    ds_read_b64_tr_b16 v[54:55], v11 offset:8704
    s_waitcnt lgkmcnt(4)
    v_mfma_f32_32x32x16_bf16 a[192:207], a[152:155], v[56:59], a[192:207]
    v_mfma_f32_32x32x16_bf16 a[224:239], a[156:159], v[56:59], a[224:239]
    v_mfma_f32_32x32x16_bf16 a[208:223], a[152:155], v[60:63], a[208:223]
    v_mfma_f32_32x32x16_bf16 a[240:255], a[156:159], v[60:63], a[240:255]
    s_waitcnt vmcnt(2)
    ds_read_b64_tr_b16 v[56:57], v10 offset:10240
    ds_read_b64_tr_b16 v[58:59], v10 offset:10752
    ds_read_b64_tr_b16 v[60:61], v11 offset:10240
    ds_read_b64_tr_b16 v[62:63], v11 offset:10752
    s_waitcnt lgkmcnt(4)
    v_mfma_f32_32x32x16_bf16 a[192:207], a[160:163], v[48:51], a[192:207]
    v_mfma_f32_32x32x16_bf16 a[224:239], a[164:167], v[48:51], a[224:239]
    v_mfma_f32_32x32x16_bf16 a[208:223], a[160:163], v[52:55], a[208:223]
    v_mfma_f32_32x32x16_bf16 a[240:255], a[164:167], v[52:55], a[240:255]
    s_waitcnt vmcnt(0) lgkmcnt(0)
    v_mfma_f32_32x32x16_bf16 a[192:207], a[168:171], v[56:59], a[192:207]
    v_mfma_f32_32x32x16_bf16 a[224:239], a[172:175], v[56:59], a[224:239]
    v_mfma_f32_32x32x16_bf16 a[208:223], a[168:171], v[60:63], a[208:223]
    v_mfma_f32_32x32x16_bf16 a[240:255], a[172:175], v[60:63], a[240:255]
    s_nop 8
    ds_write_b128 v36, a[192:195] offset:8192
    ds_write_b128 v37, a[196:199] offset:9216
    ds_write_b128 v38, a[200:203] offset:10240
    ds_write_b128 v39, a[204:207] offset:11264
    ds_write_b128 v36, a[208:211] offset:12288
    ds_write_b128 v37, a[212:215] offset:13312
    ds_write_b128 v38, a[216:219] offset:14336
    ds_write_b128 v39, a[220:223] offset:15360
    ds_write_b128 v40, a[224:227] offset:16384
    ds_write_b128 v41, a[228:231] offset:17408
    ds_write_b128 v42, a[232:235] offset:18432
    ds_write_b128 v43, a[236:239] offset:19456
    ds_write_b128 v40, a[240:243] offset:20480
    ds_write_b128 v41, a[244:247] offset:21504
    ds_write_b128 v42, a[248:251] offset:22528
    ds_write_b128 v43, a[252:255] offset:23552
    s_waitcnt lgkmcnt(0)
    s_barrier
    ds_read_b128 v[88:91], v64 offset:0
    ds_read_b128 v[92:95], v65 offset:0
    ds_read_b128 v[96:99], v66 offset:0
    ds_read_b128 v[100:103], v67 offset:0
    ds_read_b128 v[104:107], v64 offset:24576
    ds_read_b128 v[108:111], v65 offset:24576
    ds_read_b128 v[112:115], v66 offset:24576
    ds_read_b128 v[116:119], v67 offset:24576
    ds_read_b128 v[120:123], v68 offset:0
    ds_read_b128 v[124:127], v69 offset:0
    ds_read_b128 v[128:131], v70 offset:0
    ds_read_b128 v[132:135], v71 offset:0
    ds_read_b128 v[136:139], v68 offset:24576
    ds_read_b128 v[140:143], v69 offset:24576
    ds_read_b128 v[144:147], v70 offset:24576
    ds_read_b128 v[148:151], v71 offset:24576
    s_waitcnt lgkmcnt(0)
    v_pk_add_f32 v[88:89], v[88:89], v[104:105]
    v_pk_add_f32 v[90:91], v[90:91], v[106:107]
    v_pk_add_f32 v[92:93], v[92:93], v[108:109]
    v_pk_add_f32 v[94:95], v[94:95], v[110:111]
    v_pk_add_f32 v[96:97], v[96:97], v[112:113]
    v_pk_add_f32 v[98:99], v[98:99], v[114:115]
    v_pk_add_f32 v[100:101], v[100:101], v[116:117]
    v_pk_add_f32 v[102:103], v[102:103], v[118:119]
    v_pk_add_f32 v[120:121], v[120:121], v[136:137]
    v_pk_add_f32 v[122:123], v[122:123], v[138:139]
    v_pk_add_f32 v[124:125], v[124:125], v[140:141]
    v_pk_add_f32 v[126:127], v[126:127], v[142:143]
    v_pk_add_f32 v[128:129], v[128:129], v[144:145]
    v_pk_add_f32 v[130:131], v[130:131], v[146:147]
    v_pk_add_f32 v[132:133], v[132:133], v[148:149]
    v_pk_add_f32 v[134:135], v[134:135], v[150:151]
    v_pk_add_f32 v[88:89], v[88:89], v[120:121]
    v_pk_add_f32 v[90:91], v[90:91], v[122:123]
    v_pk_add_f32 v[92:93], v[92:93], v[124:125]
    v_pk_add_f32 v[94:95], v[94:95], v[126:127]
    v_pk_add_f32 v[96:97], v[96:97], v[128:129]
    v_pk_add_f32 v[98:99], v[98:99], v[130:131]
    v_pk_add_f32 v[100:101], v[100:101], v[132:133]
    v_pk_add_f32 v[102:103], v[102:103], v[134:135]
    v_cvt_pk_bf16_f32 v104, v88, v89
    v_cvt_pk_bf16_f32 v105, v90, v91
    v_cvt_pk_bf16_f32 v106, v92, v93
    v_cvt_pk_bf16_f32 v107, v94, v95
    v_cvt_pk_bf16_f32 v108, v96, v97
    v_cvt_pk_bf16_f32 v109, v98, v99
    v_cvt_pk_bf16_f32 v110, v100, v101
    v_cvt_pk_bf16_f32 v111, v102, v103
    v_lshlrev_b32 v88, 16, v104
    v_and_b32 v89, 0xffff0000, v104
    v_lshlrev_b32 v90, 16, v105
    v_and_b32 v91, 0xffff0000, v105
    v_lshlrev_b32 v92, 16, v106
    v_and_b32 v93, 0xffff0000, v106
    v_lshlrev_b32 v94, 16, v107
    v_and_b32 v95, 0xffff0000, v107
    v_lshlrev_b32 v96, 16, v108
    v_and_b32 v97, 0xffff0000, v108
    v_lshlrev_b32 v98, 16, v109
    v_and_b32 v99, 0xffff0000, v109
    v_lshlrev_b32 v100, 16, v110
    v_and_b32 v101, 0xffff0000, v110
    v_lshlrev_b32 v102, 16, v111
    v_and_b32 v103, 0xffff0000, v111
    v_add_f32 v88, v88, v232
    v_add_f32 v89, v89, v232
    v_add_f32 v90, v90, v232
    v_add_f32 v91, v91, v232
    v_add_f32 v92, v92, v233
    v_add_f32 v93, v93, v233
    v_add_f32 v94, v94, v233
    v_add_f32 v95, v95, v233
    v_add_f32 v96, v96, v234
    v_add_f32 v97, v97, v234
    v_add_f32 v98, v98, v234
    v_add_f32 v99, v99, v234
    v_add_f32 v100, v100, v235
    v_add_f32 v101, v101, v235
    v_add_f32 v102, v102, v235
    v_add_f32 v103, v103, v235
    v_cvt_pk_bf16_f32 v104, v88, v89
    v_cvt_pk_bf16_f32 v105, v90, v91
    v_cvt_pk_bf16_f32 v106, v92, v93
    v_cvt_pk_bf16_f32 v107, v94, v95
    v_cvt_pk_bf16_f32 v108, v96, v97
    v_cvt_pk_bf16_f32 v109, v98, v99
    v_cvt_pk_bf16_f32 v110, v100, v101
    v_cvt_pk_bf16_f32 v111, v102, v103
    v_lshlrev_b32 v88, 16, v104
    v_and_b32 v89, 0xffff0000, v104
    v_lshlrev_b32 v90, 16, v105
    v_and_b32 v91, 0xffff0000, v105
    v_lshlrev_b32 v92, 16, v106
    v_and_b32 v93, 0xffff0000, v106
    v_lshlrev_b32 v94, 16, v107
    v_and_b32 v95, 0xffff0000, v107
    v_lshlrev_b32 v96, 16, v108
    v_and_b32 v97, 0xffff0000, v108
    v_lshlrev_b32 v98, 16, v109
    v_and_b32 v99, 0xffff0000, v109
    v_lshlrev_b32 v100, 16, v110
    v_and_b32 v101, 0xffff0000, v110
    v_lshlrev_b32 v102, 16, v111
    v_and_b32 v103, 0xffff0000, v111
    v_mul_f32 v104, 0xbfb8aa3b, v88
    v_mul_f32 v105, 0xbfb8aa3b, v89
    v_mul_f32 v106, 0xbfb8aa3b, v90
    v_mul_f32 v107, 0xbfb8aa3b, v91
    v_mul_f32 v108, 0xbfb8aa3b, v92
    v_mul_f32 v109, 0xbfb8aa3b, v93
    v_mul_f32 v110, 0xbfb8aa3b, v94
    v_mul_f32 v111, 0xbfb8aa3b, v95
    v_mul_f32 v112, 0xbfb8aa3b, v96
    v_mul_f32 v113, 0xbfb8aa3b, v97
    v_mul_f32 v114, 0xbfb8aa3b, v98
    v_mul_f32 v115, 0xbfb8aa3b, v99
    v_mul_f32 v116, 0xbfb8aa3b, v100
    v_mul_f32 v117, 0xbfb8aa3b, v101
    v_mul_f32 v118, 0xbfb8aa3b, v102
    v_mul_f32 v119, 0xbfb8aa3b, v103
    v_exp_f32 v104, v104
    v_exp_f32 v105, v105
    v_exp_f32 v106, v106
    v_exp_f32 v107, v107
    v_exp_f32 v108, v108
    v_exp_f32 v109, v109
    v_exp_f32 v110, v110
    v_exp_f32 v111, v111
    v_exp_f32 v112, v112
    v_exp_f32 v113, v113
    v_exp_f32 v114, v114
    v_exp_f32 v115, v115
    v_exp_f32 v116, v116
    v_exp_f32 v117, v117
    v_exp_f32 v118, v118
    v_exp_f32 v119, v119
    v_add_f32 v104, 1.0, v104
    v_add_f32 v105, 1.0, v105
    v_add_f32 v106, 1.0, v106
    v_add_f32 v107, 1.0, v107
    v_add_f32 v108, 1.0, v108
    v_add_f32 v109, 1.0, v109
    v_add_f32 v110, 1.0, v110
    v_add_f32 v111, 1.0, v111
    v_add_f32 v112, 1.0, v112
    v_add_f32 v113, 1.0, v113
    v_add_f32 v114, 1.0, v114
    v_add_f32 v115, 1.0, v115
    v_add_f32 v116, 1.0, v116
    v_add_f32 v117, 1.0, v117
    v_add_f32 v118, 1.0, v118
    v_add_f32 v119, 1.0, v119
    v_rcp_f32 v104, v104
    v_rcp_f32 v105, v105
    v_rcp_f32 v106, v106
    v_rcp_f32 v107, v107
    v_rcp_f32 v108, v108
    v_rcp_f32 v109, v109
    v_rcp_f32 v110, v110
    v_rcp_f32 v111, v111
    v_rcp_f32 v112, v112
    v_rcp_f32 v113, v113
    v_rcp_f32 v114, v114
    v_rcp_f32 v115, v115
    v_rcp_f32 v116, v116
    v_rcp_f32 v117, v117
    v_rcp_f32 v118, v118
    v_rcp_f32 v119, v119
    v_pk_mul_f32 v[88:89], v[104:105], v[88:89]
    v_pk_mul_f32 v[90:91], v[106:107], v[90:91]
    v_pk_mul_f32 v[92:93], v[108:109], v[92:93]
    v_pk_mul_f32 v[94:95], v[110:111], v[94:95]
    v_pk_mul_f32 v[96:97], v[112:113], v[96:97]
    v_pk_mul_f32 v[98:99], v[114:115], v[98:99]
    v_pk_mul_f32 v[100:101], v[116:117], v[100:101]
    v_pk_mul_f32 v[102:103], v[118:119], v[102:103]
    v_cvt_pk_bf16_f32 v104, v88, v89
    v_cvt_pk_bf16_f32 v105, v90, v91
    v_cvt_pk_bf16_f32 v106, v92, v93
    v_cvt_pk_bf16_f32 v107, v94, v95
    v_cvt_pk_bf16_f32 v108, v96, v97
    v_cvt_pk_bf16_f32 v109, v98, v99
    v_cvt_pk_bf16_f32 v110, v100, v101
    v_cvt_pk_bf16_f32 v111, v102, v103
    v_lshlrev_b32 v88, 16, v104
    v_and_b32 v89, 0xffff0000, v104
    v_lshlrev_b32 v90, 16, v105
    v_and_b32 v91, 0xffff0000, v105
    v_lshlrev_b32 v92, 16, v106
    v_and_b32 v93, 0xffff0000, v106
    v_lshlrev_b32 v94, 16, v107
    v_and_b32 v95, 0xffff0000, v107
    v_lshlrev_b32 v96, 16, v108
    v_and_b32 v97, 0xffff0000, v108
    v_lshlrev_b32 v98, 16, v109
    v_and_b32 v99, 0xffff0000, v109
    v_lshlrev_b32 v100, 16, v110
    v_and_b32 v101, 0xffff0000, v110
    v_lshlrev_b32 v102, 16, v111
    v_and_b32 v103, 0xffff0000, v111
    v_pk_fma_f32 v[160:161], v[72:73], v[88:89], v[160:161]
    v_pk_fma_f32 v[162:163], v[74:75], v[90:91], v[162:163]
    s_add_u32 s77, s19, 0
    buffer_store_dwordx4 v[160:163], v24, s[56:59], s77 offen nt
    v_pk_fma_f32 v[164:165], v[76:77], v[92:93], v[164:165]
    v_pk_fma_f32 v[166:167], v[78:79], v[94:95], v[166:167]
    s_add_u32 s77, s19, 8192
    buffer_store_dwordx4 v[164:167], v24, s[56:59], s77 offen nt
    v_pk_fma_f32 v[168:169], v[80:81], v[96:97], v[168:169]
    v_pk_fma_f32 v[170:171], v[82:83], v[98:99], v[170:171]
    s_add_u32 s77, s19, 16384
    buffer_store_dwordx4 v[168:171], v24, s[56:59], s77 offen nt
    v_pk_fma_f32 v[172:173], v[84:85], v[100:101], v[172:173]
    v_pk_fma_f32 v[174:175], v[86:87], v[102:103], v[174:175]
    s_add_u32 s77, s19, 24576
    buffer_store_dwordx4 v[172:175], v24, s[56:59], s77 offen nt
kend:
    s_endpgm
.section .rodata,"a"
.p2align 6
.amdhsa_kernel recurrent_scan__ssm_conv_s5__mixer_token_mlp__prompt_kernel
  .amdhsa_next_free_vgpr 512
  .amdhsa_next_free_sgpr 102
  .amdhsa_accum_offset 256
  .amdhsa_group_segment_fixed_size 0
  .amdhsa_kernarg_size 136
  .amdhsa_user_sgpr_count 2
  .amdhsa_user_sgpr_kernarg_segment_ptr 1
  .amdhsa_system_sgpr_workgroup_id_x 1
  .amdhsa_float_denorm_mode_32 3
.end_amdhsa_kernel
```
